```python
import torch

def _softmax(x, axis=-1):
    return torch.softmax(x, dim=axis)
def _gelu(x):
    return torch.nn.functional.gelu(x, approximate="tanh")
def _silu(x):
    return torch.nn.functional.silu(x)
def _sigmoid(x):
    return torch.sigmoid(x)
def _layernorm(x, axis=-1, eps=1e-5):
    m = x.mean(dim=axis, keepdim=True)
    v = x.var(dim=axis, keepdim=True, unbiased=False)
    return (x - m) / torch.sqrt(v + eps)
def _scatter_add(tgt, idx, src, axis=0):
    return tgt.clone().index_add_(axis, idx, src)
def _segment_sum(src, seg, n):
    out = torch.zeros((n,) + src.shape[1:], dtype=src.dtype)
    return out.index_add_(0, seg, src)
def _pad(x, pw):
    flat = tuple(v for pair in reversed(pw) for v in pair)
    return torch.nn.functional.pad(x, flat)

kernel_name = 'sequential_preLN__spectral_fnet__moe_arch_mod__prompt'

def setup_inputs():

    _w = (lambda a: (lambda t: t.to(torch.bfloat16) if t.is_floating_point() else t)(torch.as_tensor(a)))
    def _A_setup():
        B, S, D = 1, 2048, 640
        ns = torch.arange(S)[:, None] * torch.arange(S)[None, :]
        nd = torch.arange(D)[:, None] * torch.arange(D)[None, :]
        Ws_re = torch.cos(-2.0 * torch.pi * ns / S).to(float)
        Ws_im = torch.sin(-2.0 * torch.pi * ns / S).to(float)
        Wd_re = torch.cos(-2.0 * torch.pi * nd / D).to(float)
        Wd_im = torch.sin(-2.0 * torch.pi * nd / D).to(float)
        return {
            "x": _w((lambda *s: torch.randn(*s, dtype=torch.bfloat16) * 0.05)(B, S, D)),
            "dft_seq_re": _w(Ws_re),
            "dft_seq_im": _w(Ws_im),
            "dft_hid_re": _w(Wd_re),
            "dft_hid_im": _w(Wd_im),
        }
    _A_in = _A_setup()

    def _B_setup():
        B, S, D, F, C = 1, 2048, 640, 1536, 2
        return {
            "x": _w((lambda *s: torch.randn(*s, dtype=torch.bfloat16) * 0.05)(B, S, D)),
            "w_r": _w((lambda *s: torch.randn(*s, dtype=torch.bfloat16) * 1.6)(D)),
            "w_gate": _w((lambda *s: torch.randn(*s, dtype=torch.bfloat16) * 0.4)(D, F)),
            "w_up": _w((lambda *s: torch.randn(*s, dtype=torch.bfloat16) * 0.4)(D, F)),
            "w_down": _w((lambda *s: torch.randn(*s, dtype=torch.bfloat16) * 0.4)(F, D)),
        }
    _B_in = _B_setup()

    return {
        "A_x": _A_in["x"],
        "A_dft_seq_re": _A_in["dft_seq_re"],
        "A_dft_seq_im": _A_in["dft_seq_im"],
        "A_dft_hid_re": _A_in["dft_hid_re"],
        "A_dft_hid_im": _A_in["dft_hid_im"],
        "B_x": _B_in["x"],
        "B_w_r": _B_in["w_r"],
        "B_w_gate": _B_in["w_gate"],
        "B_w_up": _B_in["w_up"],
        "B_w_down": _B_in["w_down"],
    }

def reference(A_x, A_dft_seq_re, A_dft_seq_im, A_dft_hid_re, A_dft_hid_im, B_x, B_w_r, B_w_gate, B_w_up, B_w_down):
    def _A_ref(x, dft_seq_re, dft_seq_im, dft_hid_re, dft_hid_im):
        a = torch.einsum("bsd,ed->bse", x, dft_hid_re)
        b = torch.einsum("bsd,ed->bse", x, dft_hid_im)
        y = torch.einsum("ts,bse->bte", dft_seq_re, a) - torch.einsum("ts,bse->bte", dft_seq_im, b)
        return y

    def _B_ref(x, w_r, w_gate, w_up, w_down):
        B, S, D = x.shape
        C = 2
        r = x @ w_r
        idx = torch.argsort(-r, axis=-1)[:, :C]
        idx_e = (lambda x, n, axis: torch.repeat_interleave(x, n, dim=axis))(idx.reshape(B, C, 1), D, axis=2)
        x_sel = (lambda x, i, axis: torch.take_along_dim(x, i, dim=axis))(x, idx_e, axis=1)
        g = _silu(x_sel @ w_gate)
        u = x_sel @ w_up
        y = (g * u) @ w_down
        r_sel = _sigmoid((lambda x, i, axis: torch.take_along_dim(x, i, dim=axis))(r, idx, axis=1))
        y = y * r_sel.reshape(B, C, 1)
        b_off = (torch.arange(B) * S).reshape(B, 1)
        flat_idx = (idx + b_off).reshape(B * C)
        zero = (x * 0.0).reshape(B * S, D)
        upd = _scatter_add(zero, flat_idx, y.reshape(B * C, D), axis=0)
        return x + upd.reshape(B, S, D)

    x = A_x
    h = x + _A_ref(_layernorm(x, axis=-1), A_dft_seq_re, A_dft_seq_im, A_dft_hid_re, A_dft_hid_im)
    h2 = h + _B_ref(_layernorm(h, axis=-1), B_w_r, B_w_gate, B_w_up, B_w_down)
    return h2
```

```asm
; @launch grid=(256,1,1) block=(512,1,1) lds=131072
.amdgcn_target "amdgcn-amd-amdhsa--gfx950"
.text
.globl sequential_preLN__spectral_fnet__moe_arch_mod__prompt_kernel
.p2align 8
.type sequential_preLN__spectral_fnet__moe_arch_mod__prompt_kernel,@function
sequential_preLN__spectral_fnet__moe_arch_mod__prompt_kernel:
    s_cmp_ge_u32 s2, 256
    s_cbranch_scc1 k_end
    s_load_dwordx2 s[4:5], s[0:1], 0
    s_load_dwordx4 s[44:47], s[0:1], 88
    s_load_dwordx8 s[52:59], s[0:1], 56
    s_load_dwordx2 s[28:29], s[0:1], 48
    v_lshrrev_b32 v1, 6, v0
    v_and_b32 v0, 63, v0
    s_and_b32 s12, s2, 7
    s_lshr_b32 s13, s2, 6
    v_readfirstlane_b32 s3, v1
    s_lshl_b32 s13, s13, 3
    s_add_u32 s12, s12, s13
    s_bfe_u32 s13, s2, 0x30003
    s_and_b32 s14, s13, 3
    s_add_u32 s14, s14, 1
    s_lshr_b32 s15, s13, 2
    v_and_b32 v1, 15, v0
    v_lshrrev_b32 v2, 4, v0
    s_mov_b32 s6, 2621440
    s_mov_b32 s7, 0x00020000
    s_mov_b32 s10, 16777216
    s_mov_b32 s11, 0x00020000
    s_cmp_lt_u32 s3, 4
    s_cbranch_scc1 k_main
k_helper:
    s_getpc_b64 s[20:21]
k_pc:
    s_sub_u32 s20, s20, k_pc-sequential_preLN__spectral_fnet__moe_arch_mod__prompt_kernel
    s_subb_u32 s21, s21, 0
    s_lshl_b32 s16, s3, 12
    s_sub_u32 s16, s16, 16384
    v_lshl_add_u32 v40, v0, 6, s16
    v_min_u32 v40, k_end-sequential_preLN__spectral_fnet__moe_arch_mod__prompt_kernel, v40
    global_load_dword v41, v40, s[20:21]
    s_mul_i32 s16, s15, 160
    s_add_u32 s16, s16, s14
    v_and_b32 v3, 3, v1
    v_mul_u32_u24 v3, 40, v3
    v_add_u32 v3, s16, v3
    v_and_b32 v4, 12, v1
    v_add_u32 v4, v3, v4
    v_add_u32 v5, 16, v4
    v_and_b32 v6, 4, v1
    v_add3_u32 v6, v3, v6, 32
    v_cvt_f32_u32 v4, v4
    v_cvt_f32_u32 v5, v5
    v_cvt_f32_u32 v6, v6
    v_lshrrev_b32 v7, 3, v1
    v_cvt_f32_u32 v7, v7
    v_mul_f32 v4, 0x3acccccd, v4
    v_mul_f32 v5, 0x3acccccd, v5
    v_mul_f32 v6, 0x3acccccd, v6
    v_mul_f32 v7, 0x3e800000, v7
    v_cos_f32 v24, v4
    v_cos_f32 v25, v5
    v_cos_f32 v26, v6
    s_sub_u32 s18, s3, 4
    s_movk_i32 s19, 31
    v_add_f32 v24, v24, v24
    v_add_f32 v25, v25, v25
    v_add_f32 v26, v26, v26
k1_hloop:
    s_lshl_b32 s16, s18, 5
    v_lshl_add_u32 v8, v2, 3, s16
    v_cvt_f32_u32 v8, v8
    s_mul_i32 s17, s18, 5120
    s_add_u32 s17, s17, 81920
    v_lshl_add_u32 v9, v0, 4, s17
    s_bitcmp1_b32 s19, 0
    s_cbranch_scc0 k1_hs0
    v_fma_f32 v10, v4, v8, 0
    v_fract_f32 v10, v10
    v_add_f32 v11, v10, v4
    v_cos_f32 v12, v10
    v_cos_f32 v13, v11
    s_nop 0
    v_fma_f32 v14, v24, v13, -v12
    v_fma_f32 v15, v24, v14, -v13
    v_fma_f32 v16, v24, v15, -v14
    v_fma_f32 v17, v24, v16, -v15
    v_fma_f32 v18, v24, v17, -v16
    v_fma_f32 v19, v24, v18, -v17
    v_cvt_pk_bf16_f32 v20, v12, v13
    v_cvt_pk_bf16_f32 v21, v14, v15
    v_cvt_pk_bf16_f32 v22, v16, v17
    v_cvt_pk_bf16_f32 v23, v18, v19
    ds_write_b128 v9, v[20:23] offset:0
k1_hs0:
    s_bitcmp1_b32 s19, 1
    s_cbranch_scc0 k1_hs1
    v_fma_f32 v10, v5, v8, 0
    v_fract_f32 v10, v10
    v_add_f32 v11, v10, v5
    v_cos_f32 v12, v10
    v_cos_f32 v13, v11
    s_nop 0
    v_fma_f32 v14, v25, v13, -v12
    v_fma_f32 v15, v25, v14, -v13
    v_fma_f32 v16, v25, v15, -v14
    v_fma_f32 v17, v25, v16, -v15
    v_fma_f32 v18, v25, v17, -v16
    v_fma_f32 v19, v25, v18, -v17
    v_cvt_pk_bf16_f32 v20, v12, v13
    v_cvt_pk_bf16_f32 v21, v14, v15
    v_cvt_pk_bf16_f32 v22, v16, v17
    v_cvt_pk_bf16_f32 v23, v18, v19
    ds_write_b128 v9, v[20:23] offset:1024
k1_hs1:
    s_bitcmp1_b32 s19, 2
    s_cbranch_scc0 k1_hs2
    v_fmaak_f32 v10, v4, v8, 0x3e800000
    v_fract_f32 v10, v10
    v_add_f32 v11, v10, v4
    v_cos_f32 v12, v10
    v_cos_f32 v13, v11
    s_nop 0
    v_fma_f32 v14, v24, v13, -v12
    v_fma_f32 v15, v24, v14, -v13
    v_fma_f32 v16, v24, v15, -v14
    v_fma_f32 v17, v24, v16, -v15
    v_fma_f32 v18, v24, v17, -v16
    v_fma_f32 v19, v24, v18, -v17
    v_cvt_pk_bf16_f32 v20, v12, v13
    v_cvt_pk_bf16_f32 v21, v14, v15
    v_cvt_pk_bf16_f32 v22, v16, v17
    v_cvt_pk_bf16_f32 v23, v18, v19
    ds_write_b128 v9, v[20:23] offset:2048
k1_hs2:
    s_bitcmp1_b32 s19, 3
    s_cbranch_scc0 k1_hs3
    v_fmaak_f32 v10, v5, v8, 0x3e800000
    v_fract_f32 v10, v10
    v_add_f32 v11, v10, v5
    v_cos_f32 v12, v10
    v_cos_f32 v13, v11
    s_nop 0
    v_fma_f32 v14, v25, v13, -v12
    v_fma_f32 v15, v25, v14, -v13
    v_fma_f32 v16, v25, v15, -v14
    v_fma_f32 v17, v25, v16, -v15
    v_fma_f32 v18, v25, v17, -v16
    v_fma_f32 v19, v25, v18, -v17
    v_cvt_pk_bf16_f32 v20, v12, v13
    v_cvt_pk_bf16_f32 v21, v14, v15
    v_cvt_pk_bf16_f32 v22, v16, v17
    v_cvt_pk_bf16_f32 v23, v18, v19
    ds_write_b128 v9, v[20:23] offset:3072
k1_hs3:
    s_bitcmp1_b32 s19, 4
    s_cbranch_scc0 k1_hs4
    v_fma_f32 v10, v6, v8, v7
    v_fract_f32 v10, v10
    v_add_f32 v11, v10, v6
    v_cos_f32 v12, v10
    v_cos_f32 v13, v11
    s_nop 0
    v_fma_f32 v14, v26, v13, -v12
    v_fma_f32 v15, v26, v14, -v13
    v_fma_f32 v16, v26, v15, -v14
    v_fma_f32 v17, v26, v16, -v15
    v_fma_f32 v18, v26, v17, -v16
    v_fma_f32 v19, v26, v18, -v17
    v_cvt_pk_bf16_f32 v20, v12, v13
    v_cvt_pk_bf16_f32 v21, v14, v15
    v_cvt_pk_bf16_f32 v22, v16, v17
    v_cvt_pk_bf16_f32 v23, v18, v19
    ds_write_b128 v9, v[20:23] offset:4096
k1_hs4:
    s_cmp_eq_u32 s18, 4
    s_cbranch_scc1 k1_hdone
    s_lshl_b32 s19, 1, s18
    s_cmp_eq_u32 s18, 0
    s_cselect_b32 s19, 17, s19
    s_mov_b32 s18, 4
    s_branch k1_hloop
k1_hdone:
    v_mov_b32 v36, -1
    v_mov_b32 v37, -1
    v_mov_b32 v38, -1
    v_mov_b32 v39, -1
    v_lshlrev_b32 v3, 4, v0
    s_waitcnt lgkmcnt(0)
    s_barrier
    s_mov_b32 s8, s46
    s_mov_b32 s9, s47
    s_mov_b32 s32, s58
    s_mov_b32 s33, s59
    s_mov_b32 s46, 256
    s_mov_b32 s47, 0x00020000
    s_mov_b32 s30, 1280
    s_mov_b32 s31, 0x00020000
    s_mov_b32 s34, 2621440
    s_mov_b32 s35, 0x00020000
    s_lshl_b32 s51, s2, 3
    s_add_u32 s51, s51, s3
    s_cmp_lg_u32 s51, 4
    s_cbranch_scc1 k1_hd2
    s_mov_b32 s20, 2621440
k_clr0:
    buffer_store_dwordx4 v[36:39], v3, s[8:11], s20 offen sc1
    s_addk_i32 s20, 1024
    s_cmp_lt_u32 s20, 2637824
    s_cbranch_scc1 k_clr0
k1_hd2:
    s_mov_b32 s50, 0
    s_branch k2_pre
k_h2:
    s_cmp_lt_u32 s3, 6
    s_cbranch_scc1 k_h45
    s_and_b32 s20, s2, 7
    s_lshr_b32 s21, s2, 3
    v_mul_u32_u24 v40, 86, v0
    v_lshrrev_b32 v40, 8, v40
    v_mul_u32_u24 v42, 3, v40
    v_sub_u32 v42, v0, v42
    v_mul_u32_u24 v40, 3072, v40
    v_lshl_add_u32 v40, v42, 7, v40
    s_mul_i32 s21, s21, 61440
    s_mul_i32 s20, s20, 384
    s_add_u32 s20, s20, s21
    s_cmp_eq_u32 s3, 6
    s_cselect_b32 s4, s52, s54
    s_cselect_b32 s5, s53, s55
    s_mov_b32 s6, 1966080
    s_barrier
    buffer_load_dword v41, v40, s[4:7], s20 offen
    s_branch k_hb2
k_h45:
    s_barrier
    s_mul_i32 s20, s2, 6144
    s_add_u32 s20, s20, 3145728
    s_cmp_eq_u32 s3, 5
    s_cbranch_scc1 k_clr
    s_cmp_lg_u32 s2, 0
    s_cbranch_scc1 k_hb2
    s_waitcnt vmcnt(0)
    buffer_store_dword v36, v29, s[44:47], 0 offen sc1
    s_mov_b32 s20, 2637824
k_clr:
    s_add_u32 s21, s20, 4096
    buffer_store_dwordx4 v[36:39], v28, s[8:11], s20 offen sc1
    buffer_store_dwordx4 v[36:39], v28, s[8:11], s20 offen offset:1024 sc1
    buffer_store_dwordx4 v[36:39], v28, s[8:11], s20 offen offset:2048 sc1
    buffer_store_dwordx4 v[36:39], v28, s[8:11], s20 offen offset:3072 sc1
    buffer_store_dwordx4 v[36:39], v28, s[8:11], s21 offen sc1
    buffer_store_dwordx4 v[36:39], v28, s[8:11], s21 offen offset:1024 sc1
k_hb2:
    s_barrier
    s_branch k2_join
k_main:
    v_lshrrev_b32 v3, 2, v0
    s_lshl_b32 s16, s3, 4
    v_add_u32 v3, s16, v3
    s_mov_b32 s17, 40960
    v_mul_lo_u32 v3, v3, s17
    v_lshrrev_b32 v4, 5, v0
    v_mul_u32_u24 v4, 3, v4
    v_and_b32 v5, 3, v0
    v_xor_b32 v4, v4, v5
    v_lshl_add_u32 v3, v4, 4, v3
    s_mul_i32 s18, s12, 1280
    s_mul_i32 s19, s3, 20480
    s_mov_b32 m0, s19
    s_add_u32 s20, s18, 384
    s_lshl_b32 s21, s13, 2
    s_add_u32 s21, s21, s3
    s_mul_i32 s21, s21, 81920
    s_add_u32 s21, s21, s18
    v_lshrrev_b32 v6, 5, v0
    v_mul_u32_u24 v6, 40960, v6
    v_and_b32 v7, 31, v0
    v_med3_u32 v7, v7, 6, 19
    v_lshl_add_u32 v6, v7, 6, v6
    s_waitcnt lgkmcnt(0)
    buffer_load_dword v239, v6, s[4:7], s21 offen
k1_dma:
    buffer_load_dwordx4 v3, s[4:7], s18 offen lds
    s_addk_i32 s18, 64
    s_addk_i32 m0, 1024
    s_cmp_lt_u32 s18, s20
    s_cbranch_scc1 k1_dma
    s_mov_b32 s8, s46
    s_mov_b32 s9, s47
    s_mov_b32 s32, s58
    s_mov_b32 s33, s59
    s_mov_b32 s46, 256
    s_mov_b32 s47, 0x00020000
    s_mov_b32 s30, 1280
    s_mov_b32 s31, 0x00020000
    s_mov_b32 s34, 2621440
    s_mov_b32 s35, 0x00020000
    v_add_u32 v4, s16, v1
    v_cvt_f32_u32 v4, v4
    v_lshlrev_b32 v5, 8, v2
    v_add_u32 v5, s12, v5
    v_cvt_f32_u32 v5, v5
    s_mul_i32 s21, s14, 3
    v_cvt_f32_u32 v6, s21
    v_mul_f32 v5, v4, v5
    v_mul_f32 v6, 0x3e800000, v6
    v_mul_f32 v7, 0x3c800000, v4
    v_fmac_f32 v6, 0x3a000000, v5
    v_fract_f32 v6, v6
    s_and_b32 s21, s14, 1
    s_lshl_b32 s22, s21, 31
    s_or_b32 s22, s22, 0x3f800000
    s_and_b32 s23, s14, 2
    s_lshl_b32 s23, s23, 30
    s_or_b32 s23, s23, 0x3f800000
    s_cmp_eq_u32 s21, 1
    s_cselect_b32 s24, s23, 0
    s_cselect_b32 s23, 0, s23
    s_xor_b32 s25, s24, 0x80000000
    v_mov_b32 v12, s24
    v_mov_b32 v13, s25
    v_cmp_gt_u32 vcc, 8, v1
    v_lshrrev_b32 v4, 3, v1
    v_mul_u32_u24 v4, 3, v4
    v_cndmask_b32 v12, v12, v13, vcc
    v_xor_b32 v4, v4, v2
    v_lshlrev_b32 v4, 4, v4
    v_lshl_add_u32 v4, v1, 6, v4
    v_add_u32 v4, s19, v4
    v_lshlrev_b32 v19, 4, v0
    v_add_u32 v19, 81920, v19
    v_lshlrev_b32 v13, 2, v2
    v_sub_u32 v13, v1, v13
    v_mov_b32 v18, 1.0
    v_mov_b32 v224, 0x3f803f80
    v_cmp_eq_u32 s[36:37], 0, v13
    v_mov_b32 v225, 0x3f803f80
    v_cmp_eq_u32 s[38:39], 1, v13
    v_mov_b32 v226, 0x3f803f80
    v_cmp_eq_u32 s[40:41], 2, v13
    v_mov_b32 v227, 0x3f803f80
    v_cmp_eq_u32 s[42:43], 3, v13
    s_mov_b32 s50, 0
    s_barrier
    ds_read_b128 v[20:23], v19 offset:0
    ds_read_b128 v[24:27], v19 offset:1024
    ds_read_b128 v[28:31], v19 offset:2048
    ds_read_b128 v[32:35], v19 offset:3072
    ds_read_b128 v[36:39], v19 offset:4096
    s_waitcnt vmcnt(5)
    ds_read_b128 v[120:123], v4 offset:0
    ds_read_b128 v[40:43], v19 offset:5120
    ds_read_b128 v[44:47], v19 offset:6144
    ds_read_b128 v[48:51], v19 offset:7168
    ds_read_b128 v[52:55], v19 offset:8192
    ds_read_b128 v[56:59], v19 offset:9216
    s_waitcnt vmcnt(4)
    ds_read_b128 v[124:127], v4 offset:1024
    ds_read_b128 v[60:63], v19 offset:10240
    ds_read_b128 v[64:67], v19 offset:11264
    ds_read_b128 v[68:71], v19 offset:12288
    ds_read_b128 v[72:75], v19 offset:13312
    ds_read_b128 v[76:79], v19 offset:14336
    s_waitcnt vmcnt(3)
    ds_read_b128 v[128:131], v4 offset:2048
    ds_read_b128 v[80:83], v19 offset:15360
    ds_read_b128 v[84:87], v19 offset:16384
    ds_read_b128 v[88:91], v19 offset:17408
    ds_read_b128 v[92:95], v19 offset:18432
    ds_read_b128 v[96:99], v19 offset:19456
    s_waitcnt vmcnt(2)
    ds_read_b128 v[172:175], v4 offset:3072
    ds_read_b128 v[100:103], v19 offset:20480
    ds_read_b128 v[104:107], v19 offset:21504
    ds_read_b128 v[108:111], v19 offset:22528
    ds_read_b128 v[112:115], v19 offset:23552
    ds_read_b128 v[116:119], v19 offset:24576
    s_waitcnt vmcnt(1)
    ds_read_b128 v[176:179], v4 offset:4096
    buffer_load_dwordx4 v3, s[4:7], s18 offen lds
    s_addk_i32 m0, 1024
    s_addk_i32 s18, 64
    s_waitcnt lgkmcnt(15)
    v_mfma_f32_16x16x32_bf16 v[132:135], v[120:123], v[20:23], 0
    v_cos_f32 v8, v6
    v_sin_f32 v9, v6
    v_add_f32 v6, v6, v7
    v_mfma_f32_16x16x32_bf16 v[136:139], v[120:123], v[24:27], 0
    v_cos_f32 v10, v6
    v_sin_f32 v11, v6
    v_add_f32 v6, v6, v7
    v_mfma_f32_16x16x32_bf16 v[140:143], v[120:123], v[28:31], 0
    v_cvt_pk_bf16_f32 v200, v8, v10
    v_cvt_pk_bf16_f32 v216, v9, v11
    v_cvt_pk_bf16_f32 v208, -v9, -v11
    v_mfma_f32_16x16x32_bf16 v[144:147], v[120:123], v[32:35], 0
    v_cos_f32 v8, v6
    v_sin_f32 v9, v6
    v_add_f32 v6, v6, v7
    v_mfma_f32_16x16x32_bf16 v[148:151], v[120:123], v[36:39], 0
    v_cos_f32 v10, v6
    v_sin_f32 v11, v6
    v_add_f32 v6, v6, v7
    v_mfma_f32_16x16x32_bf16 v[196:199], v[120:123], v[120:123], 0
    v_cvt_pk_bf16_f32 v201, v8, v10
    v_cvt_pk_bf16_f32 v217, v9, v11
    v_cvt_pk_bf16_f32 v209, -v9, -v11
    v_mfma_f32_16x16x32_bf16 v[192:195], v[120:123], v[224:227], 0
    buffer_load_dwordx4 v3, s[4:7], s18 offen lds
    s_addk_i32 m0, 1024
    s_addk_i32 s18, 64
    s_waitcnt lgkmcnt(15)
    v_mfma_f32_16x16x32_bf16 v[132:135], v[124:127], v[40:43], v[132:135]
    v_cos_f32 v8, v6
    v_sin_f32 v9, v6
    v_add_f32 v6, v6, v7
    v_mfma_f32_16x16x32_bf16 v[136:139], v[124:127], v[44:47], v[136:139]
    v_cos_f32 v10, v6
    v_sin_f32 v11, v6
    v_add_f32 v6, v6, v7
    v_mfma_f32_16x16x32_bf16 v[140:143], v[124:127], v[48:51], v[140:143]
    v_cvt_pk_bf16_f32 v202, v8, v10
    v_cvt_pk_bf16_f32 v218, v9, v11
    v_cvt_pk_bf16_f32 v210, -v9, -v11
    v_mfma_f32_16x16x32_bf16 v[144:147], v[124:127], v[52:55], v[144:147]
    v_cos_f32 v8, v6
    v_sin_f32 v9, v6
    v_add_f32 v6, v6, v7
    v_mfma_f32_16x16x32_bf16 v[148:151], v[124:127], v[56:59], v[148:151]
    v_cos_f32 v10, v6
    v_sin_f32 v11, v6
    v_add_f32 v6, v6, v7
    v_mfma_f32_16x16x32_bf16 v[196:199], v[124:127], v[124:127], v[196:199]
    v_cvt_pk_bf16_f32 v203, v8, v10
    v_cvt_pk_bf16_f32 v219, v9, v11
    v_cvt_pk_bf16_f32 v211, -v9, -v11
    v_mfma_f32_16x16x32_bf16 v[192:195], v[124:127], v[224:227], v[192:195]
    buffer_load_dwordx4 v3, s[4:7], s18 offen lds
    s_addk_i32 m0, 1024
    s_addk_i32 s18, 64
    s_waitcnt lgkmcnt(12)
    v_mfma_f32_16x16x32_bf16 v[132:135], v[128:131], v[60:63], v[132:135]
    v_fmac_f32 v6, 0x41c00000, v7
    v_fract_f32 v6, v6
    v_mfma_f32_16x16x32_bf16 v[136:139], v[128:131], v[64:67], v[136:139]
    v_cos_f32 v8, v6
    v_sin_f32 v9, v6
    v_mfma_f32_16x16x32_bf16 v[140:143], v[128:131], v[68:71], v[140:143]
    v_add_f32 v6, v6, v7
    v_cos_f32 v10, v6
    v_mfma_f32_16x16x32_bf16 v[144:147], v[128:131], v[72:75], v[144:147]
    v_sin_f32 v11, v6
    v_add_f32 v6, v6, v7
    v_mfma_f32_16x16x32_bf16 v[148:151], v[128:131], v[76:79], v[148:151]
    v_cvt_pk_bf16_f32 v204, v8, v10
    v_cvt_pk_bf16_f32 v220, v9, v11
    v_mfma_f32_16x16x32_bf16 v[196:199], v[128:131], v[128:131], v[196:199]
    v_cvt_pk_bf16_f32 v212, -v9, -v11
    v_mfma_f32_16x16x32_bf16 v[192:195], v[128:131], v[224:227], v[192:195]
    buffer_load_dwordx4 v3, s[4:7], s18 offen lds
    s_addk_i32 m0, 1024
    s_addk_i32 s18, 64
    s_waitcnt vmcnt(4)
    ds_read_b128 v[128:131], v4 offset:5120
    s_waitcnt lgkmcnt(7)
    v_mfma_f32_16x16x32_bf16 v[132:135], v[172:175], v[80:83], v[132:135]
    v_cos_f32 v8, v6
    v_sin_f32 v9, v6
    v_mfma_f32_16x16x32_bf16 v[136:139], v[172:175], v[84:87], v[136:139]
    v_add_f32 v6, v6, v7
    v_cos_f32 v10, v6
    v_mfma_f32_16x16x32_bf16 v[140:143], v[172:175], v[88:91], v[140:143]
    v_sin_f32 v11, v6
    v_add_f32 v6, v6, v7
    v_mfma_f32_16x16x32_bf16 v[144:147], v[172:175], v[92:95], v[144:147]
    v_cvt_pk_bf16_f32 v205, v8, v10
    v_cvt_pk_bf16_f32 v221, v9, v11
    v_mfma_f32_16x16x32_bf16 v[148:151], v[172:175], v[96:99], v[148:151]
    v_cvt_pk_bf16_f32 v213, -v9, -v11
    v_mfma_f32_16x16x32_bf16 v[196:199], v[172:175], v[172:175], v[196:199]
    v_mfma_f32_16x16x32_bf16 v[192:195], v[172:175], v[224:227], v[192:195]
    buffer_load_dwordx4 v3, s[4:7], s18 offen lds
    s_addk_i32 m0, 1024
    s_addk_i32 s18, 64
    s_waitcnt vmcnt(4)
    ds_read_b128 v[120:123], v4 offset:6144
    s_waitcnt lgkmcnt(2)
    v_mfma_f32_16x16x32_bf16 v[132:135], v[176:179], v[100:103], v[132:135]
    v_cos_f32 v8, v6
    v_sin_f32 v9, v6
    v_mfma_f32_16x16x32_bf16 v[136:139], v[176:179], v[104:107], v[136:139]
    v_add_f32 v6, v6, v7
    v_cos_f32 v10, v6
    v_mfma_f32_16x16x32_bf16 v[140:143], v[176:179], v[108:111], v[140:143]
    v_sin_f32 v11, v6
    v_add_f32 v6, v6, v7
    v_mfma_f32_16x16x32_bf16 v[144:147], v[176:179], v[112:115], v[144:147]
    v_cvt_pk_bf16_f32 v206, v8, v10
    v_cvt_pk_bf16_f32 v222, v9, v11
    v_mfma_f32_16x16x32_bf16 v[148:151], v[176:179], v[116:119], v[148:151]
    v_cvt_pk_bf16_f32 v214, -v9, -v11
    v_mfma_f32_16x16x32_bf16 v[196:199], v[176:179], v[176:179], v[196:199]
    v_mfma_f32_16x16x32_bf16 v[192:195], v[176:179], v[224:227], v[192:195]
    buffer_load_dwordx4 v3, s[4:7], s18 offen lds
    s_addk_i32 m0, 1024
    s_addk_i32 s18, 64
    s_waitcnt vmcnt(4)
    ds_read_b128 v[124:127], v4 offset:7168
    s_waitcnt lgkmcnt(2)
    v_mfma_f32_16x16x32_bf16 v[152:155], v[128:131], v[20:23], 0
    v_cos_f32 v8, v6
    v_sin_f32 v9, v6
    v_mfma_f32_16x16x32_bf16 v[156:159], v[128:131], v[24:27], 0
    v_add_f32 v6, v6, v7
    v_cos_f32 v10, v6
    v_mfma_f32_16x16x32_bf16 v[160:163], v[128:131], v[28:31], 0
    v_sin_f32 v11, v6
    v_add_f32 v6, v6, v7
    v_mfma_f32_16x16x32_bf16 v[164:167], v[128:131], v[32:35], 0
    v_cvt_pk_bf16_f32 v207, v8, v10
    v_cvt_pk_bf16_f32 v223, v9, v11
    v_mfma_f32_16x16x32_bf16 v[168:171], v[128:131], v[36:39], 0
    v_cvt_pk_bf16_f32 v215, -v9, -v11
    v_mfma_f32_16x16x32_bf16 v[196:199], v[128:131], v[128:131], v[196:199]
    v_mfma_f32_16x16x32_bf16 v[192:195], v[128:131], v[224:227], v[192:195]
    buffer_load_dwordx4 v3, s[4:7], s18 offen lds
    s_addk_i32 m0, 1024
    s_addk_i32 s18, 64
    s_waitcnt vmcnt(4)
    ds_read_b128 v[128:131], v4 offset:8192
    s_waitcnt lgkmcnt(2)
    v_mfma_f32_16x16x32_bf16 v[152:155], v[120:123], v[40:43], v[152:155]
    v_mul_f32 v132, s22, v132
    v_mfma_f32_16x16x32_bf16 v[156:159], v[120:123], v[44:47], v[156:159]
    v_mul_f32 v133, s22, v133
    v_mfma_f32_16x16x32_bf16 v[160:163], v[120:123], v[48:51], v[160:163]
    v_mul_f32 v134, s22, v134
    v_mfma_f32_16x16x32_bf16 v[164:167], v[120:123], v[52:55], v[164:167]
    v_mul_f32 v135, s22, v135
    v_mfma_f32_16x16x32_bf16 v[168:171], v[120:123], v[56:59], v[168:171]
    v_mul_f32 v136, s22, v136
    v_mfma_f32_16x16x32_bf16 v[196:199], v[120:123], v[120:123], v[196:199]
    v_mfma_f32_16x16x32_bf16 v[192:195], v[120:123], v[224:227], v[192:195]
    buffer_load_dwordx4 v3, s[4:7], s18 offen lds
    s_addk_i32 m0, 1024
    s_addk_i32 s18, 64
    s_waitcnt vmcnt(4)
    ds_read_b128 v[120:123], v4 offset:9216
    s_waitcnt lgkmcnt(2)
    v_mfma_f32_16x16x32_bf16 v[152:155], v[124:127], v[60:63], v[152:155]
    v_mul_f32 v137, s22, v137
    v_mfma_f32_16x16x32_bf16 v[156:159], v[124:127], v[64:67], v[156:159]
    v_mul_f32 v138, s22, v138
    v_mfma_f32_16x16x32_bf16 v[160:163], v[124:127], v[68:71], v[160:163]
    v_mul_f32 v139, s22, v139
    v_mfma_f32_16x16x32_bf16 v[164:167], v[124:127], v[72:75], v[164:167]
    v_mul_f32 v140, s22, v140
    v_mfma_f32_16x16x32_bf16 v[168:171], v[124:127], v[76:79], v[168:171]
    v_mul_f32 v141, s22, v141
    v_mfma_f32_16x16x32_bf16 v[196:199], v[124:127], v[124:127], v[196:199]
    v_mfma_f32_16x16x32_bf16 v[192:195], v[124:127], v[224:227], v[192:195]
    buffer_load_dwordx4 v3, s[4:7], s18 offen lds
    s_addk_i32 m0, 1024
    s_addk_i32 s18, 64
    s_waitcnt vmcnt(4)
    ds_read_b128 v[124:127], v4 offset:10240
    s_waitcnt lgkmcnt(2)
    v_mfma_f32_16x16x32_bf16 v[152:155], v[128:131], v[80:83], v[152:155]
    v_mul_f32 v142, s22, v142
    v_mfma_f32_16x16x32_bf16 v[156:159], v[128:131], v[84:87], v[156:159]
    v_mul_f32 v143, s22, v143
    v_mfma_f32_16x16x32_bf16 v[160:163], v[128:131], v[88:91], v[160:163]
    v_mul_f32 v144, s22, v144
    v_mfma_f32_16x16x32_bf16 v[164:167], v[128:131], v[92:95], v[164:167]
    v_mul_f32 v145, s22, v145
    v_mfma_f32_16x16x32_bf16 v[168:171], v[128:131], v[96:99], v[168:171]
    v_mul_f32 v146, s22, v146
    v_mfma_f32_16x16x32_bf16 v[196:199], v[128:131], v[128:131], v[196:199]
    v_mfma_f32_16x16x32_bf16 v[192:195], v[128:131], v[224:227], v[192:195]
    buffer_load_dwordx4 v3, s[4:7], s18 offen lds
    s_addk_i32 m0, 1024
    s_addk_i32 s18, 64
    s_waitcnt vmcnt(4)
    ds_read_b128 v[128:131], v4 offset:11264
    s_waitcnt lgkmcnt(2)
    v_mfma_f32_16x16x32_bf16 v[152:155], v[120:123], v[100:103], v[152:155]
    v_mul_f32 v147, s22, v147
    v_mfma_f32_16x16x32_bf16 v[156:159], v[120:123], v[104:107], v[156:159]
    v_mul_f32 v148, s22, v148
    v_mfma_f32_16x16x32_bf16 v[160:163], v[120:123], v[108:111], v[160:163]
    v_mul_f32 v149, s22, v149
    v_mfma_f32_16x16x32_bf16 v[164:167], v[120:123], v[112:115], v[164:167]
    v_mul_f32 v150, s22, v150
    v_mfma_f32_16x16x32_bf16 v[168:171], v[120:123], v[116:119], v[168:171]
    v_mul_f32 v151, s22, v151
    v_mfma_f32_16x16x32_bf16 v[196:199], v[120:123], v[120:123], v[196:199]
    v_mfma_f32_16x16x32_bf16 v[192:195], v[120:123], v[224:227], v[192:195]
    buffer_load_dwordx4 v3, s[4:7], s18 offen lds
    s_addk_i32 m0, 1024
    s_addk_i32 s18, 64
    s_waitcnt vmcnt(4)
    ds_read_b128 v[120:123], v4 offset:12288
    s_waitcnt lgkmcnt(2)
    v_mfma_f32_16x16x32_bf16 v[132:135], v[124:127], v[20:23], v[132:135]
    v_mfma_f32_16x16x32_bf16 v[136:139], v[124:127], v[24:27], v[136:139]
    v_mfma_f32_16x16x32_bf16 v[140:143], v[124:127], v[28:31], v[140:143]
    v_mfma_f32_16x16x32_bf16 v[144:147], v[124:127], v[32:35], v[144:147]
    v_mfma_f32_16x16x32_bf16 v[148:151], v[124:127], v[36:39], v[148:151]
    v_mfma_f32_16x16x32_bf16 v[196:199], v[124:127], v[124:127], v[196:199]
    v_mfma_f32_16x16x32_bf16 v[192:195], v[124:127], v[224:227], v[192:195]
    buffer_load_dwordx4 v3, s[4:7], s18 offen lds
    s_addk_i32 m0, 1024
    s_addk_i32 s18, 64
    s_waitcnt vmcnt(4)
    ds_read_b128 v[124:127], v4 offset:13312
    s_waitcnt lgkmcnt(2)
    v_mfma_f32_16x16x32_bf16 v[132:135], v[128:131], v[40:43], v[132:135]
    v_mul_f32 v152, s22, v152
    v_mfma_f32_16x16x32_bf16 v[136:139], v[128:131], v[44:47], v[136:139]
    v_mul_f32 v153, s22, v153
    v_mfma_f32_16x16x32_bf16 v[140:143], v[128:131], v[48:51], v[140:143]
    v_mul_f32 v154, s22, v154
    v_mfma_f32_16x16x32_bf16 v[144:147], v[128:131], v[52:55], v[144:147]
    v_mul_f32 v155, s22, v155
    v_mfma_f32_16x16x32_bf16 v[148:151], v[128:131], v[56:59], v[148:151]
    v_mul_f32 v156, s22, v156
    v_mfma_f32_16x16x32_bf16 v[196:199], v[128:131], v[128:131], v[196:199]
    v_mfma_f32_16x16x32_bf16 v[192:195], v[128:131], v[224:227], v[192:195]
    buffer_load_dwordx4 v3, s[4:7], s18 offen lds
    s_addk_i32 m0, 1024
    s_addk_i32 s18, 64
    s_waitcnt vmcnt(4)
    ds_read_b128 v[128:131], v4 offset:14336
    s_waitcnt lgkmcnt(2)
    v_mfma_f32_16x16x32_bf16 v[132:135], v[120:123], v[60:63], v[132:135]
    v_mul_f32 v157, s22, v157
    v_mfma_f32_16x16x32_bf16 v[136:139], v[120:123], v[64:67], v[136:139]
    v_mul_f32 v158, s22, v158
    v_mfma_f32_16x16x32_bf16 v[140:143], v[120:123], v[68:71], v[140:143]
    v_mul_f32 v159, s22, v159
    v_mfma_f32_16x16x32_bf16 v[144:147], v[120:123], v[72:75], v[144:147]
    v_mul_f32 v160, s22, v160
    v_mfma_f32_16x16x32_bf16 v[148:151], v[120:123], v[76:79], v[148:151]
    v_mul_f32 v161, s22, v161
    v_mfma_f32_16x16x32_bf16 v[196:199], v[120:123], v[120:123], v[196:199]
    v_mfma_f32_16x16x32_bf16 v[192:195], v[120:123], v[224:227], v[192:195]
    buffer_load_dwordx4 v3, s[4:7], s18 offen lds
    s_addk_i32 m0, 1024
    s_addk_i32 s18, 64
    s_waitcnt vmcnt(4)
    ds_read_b128 v[120:123], v4 offset:15360
    s_waitcnt lgkmcnt(2)
    v_mfma_f32_16x16x32_bf16 v[132:135], v[124:127], v[80:83], v[132:135]
    v_mul_f32 v162, s22, v162
    v_mfma_f32_16x16x32_bf16 v[136:139], v[124:127], v[84:87], v[136:139]
    v_mul_f32 v163, s22, v163
    v_mfma_f32_16x16x32_bf16 v[140:143], v[124:127], v[88:91], v[140:143]
    v_mul_f32 v164, s22, v164
    v_mfma_f32_16x16x32_bf16 v[144:147], v[124:127], v[92:95], v[144:147]
    v_mul_f32 v165, s22, v165
    v_mfma_f32_16x16x32_bf16 v[148:151], v[124:127], v[96:99], v[148:151]
    v_mul_f32 v166, s22, v166
    v_mfma_f32_16x16x32_bf16 v[196:199], v[124:127], v[124:127], v[196:199]
    v_mfma_f32_16x16x32_bf16 v[192:195], v[124:127], v[224:227], v[192:195]
    s_barrier
    s_waitcnt vmcnt(3)
    ds_read_b128 v[124:127], v4 offset:16384
    s_waitcnt lgkmcnt(2)
    v_mfma_f32_16x16x32_bf16 v[132:135], v[128:131], v[100:103], v[132:135]
    v_mul_f32 v167, s22, v167
    v_mfma_f32_16x16x32_bf16 v[136:139], v[128:131], v[104:107], v[136:139]
    v_mul_f32 v168, s22, v168
    v_mfma_f32_16x16x32_bf16 v[140:143], v[128:131], v[108:111], v[140:143]
    v_mul_f32 v169, s22, v169
    v_mfma_f32_16x16x32_bf16 v[144:147], v[128:131], v[112:115], v[144:147]
    v_mul_f32 v170, s22, v170
    v_mfma_f32_16x16x32_bf16 v[148:151], v[128:131], v[116:119], v[148:151]
    v_mul_f32 v171, s22, v171
    v_mfma_f32_16x16x32_bf16 v[196:199], v[128:131], v[128:131], v[196:199]
    v_mfma_f32_16x16x32_bf16 v[192:195], v[128:131], v[224:227], v[192:195]
    s_waitcnt vmcnt(2)
    ds_read_b128 v[128:131], v4 offset:17408
    s_waitcnt lgkmcnt(2)
    v_mfma_f32_16x16x32_bf16 v[152:155], v[120:123], v[20:23], v[152:155]
    s_nop 0
    s_nop 0
    v_mfma_f32_16x16x32_bf16 v[156:159], v[120:123], v[24:27], v[156:159]
    v_mul_f32 v172, s23, v132
    v_mul_f32 v180, s23, v140
    v_mfma_f32_16x16x32_bf16 v[160:163], v[120:123], v[28:31], v[160:163]
    v_fmac_f32 v172, s25, v140
    v_fmac_f32 v180, s24, v132
    v_mfma_f32_16x16x32_bf16 v[164:167], v[120:123], v[32:35], v[164:167]
    v_mul_f32 v173, s23, v133
    v_mul_f32 v181, s23, v141
    v_mfma_f32_16x16x32_bf16 v[168:171], v[120:123], v[36:39], v[168:171]
    v_fmac_f32 v173, s25, v141
    v_fmac_f32 v181, s24, v133
    v_mfma_f32_16x16x32_bf16 v[196:199], v[120:123], v[120:123], v[196:199]
    v_mul_f32 v174, s23, v134
    v_mul_f32 v182, s23, v142
    v_mfma_f32_16x16x32_bf16 v[192:195], v[120:123], v[224:227], v[192:195]
    s_waitcnt vmcnt(1)
    ds_read_b128 v[120:123], v4 offset:18432
    s_waitcnt lgkmcnt(2)
    v_mfma_f32_16x16x32_bf16 v[152:155], v[124:127], v[40:43], v[152:155]
    v_fmac_f32 v174, s25, v142
    v_fmac_f32 v182, s24, v134
    v_mfma_f32_16x16x32_bf16 v[156:159], v[124:127], v[44:47], v[156:159]
    v_mul_f32 v175, s23, v135
    v_mul_f32 v183, s23, v143
    v_mfma_f32_16x16x32_bf16 v[160:163], v[124:127], v[48:51], v[160:163]
    v_fmac_f32 v175, s25, v143
    v_fmac_f32 v183, s24, v135
    v_mfma_f32_16x16x32_bf16 v[164:167], v[124:127], v[52:55], v[164:167]
    v_mul_f32 v176, s23, v136
    v_mul_f32 v184, s23, v144
    v_mfma_f32_16x16x32_bf16 v[168:171], v[124:127], v[56:59], v[168:171]
    v_fmac_f32 v176, s25, v144
    v_fmac_f32 v184, s24, v136
    v_mfma_f32_16x16x32_bf16 v[196:199], v[124:127], v[124:127], v[196:199]
    v_mfma_f32_16x16x32_bf16 v[192:195], v[124:127], v[224:227], v[192:195]
    s_waitcnt vmcnt(0)
    ds_read_b128 v[124:127], v4 offset:19456
    s_waitcnt lgkmcnt(2)
    v_mfma_f32_16x16x32_bf16 v[152:155], v[128:131], v[60:63], v[152:155]
    v_mul_f32 v177, s23, v137
    v_mul_f32 v185, s23, v145
    v_mfma_f32_16x16x32_bf16 v[156:159], v[128:131], v[64:67], v[156:159]
    v_fmac_f32 v177, s25, v145
    v_fmac_f32 v185, s24, v137
    v_mfma_f32_16x16x32_bf16 v[160:163], v[128:131], v[68:71], v[160:163]
    v_mul_f32 v178, s23, v138
    v_mul_f32 v186, s23, v146
    v_mfma_f32_16x16x32_bf16 v[164:167], v[128:131], v[72:75], v[164:167]
    v_fmac_f32 v178, s25, v146
    v_fmac_f32 v186, s24, v138
    v_mfma_f32_16x16x32_bf16 v[168:171], v[128:131], v[76:79], v[168:171]
    v_mul_f32 v179, s23, v139
    v_mul_f32 v187, s23, v147
    v_mfma_f32_16x16x32_bf16 v[196:199], v[128:131], v[128:131], v[196:199]
    v_mfma_f32_16x16x32_bf16 v[192:195], v[128:131], v[224:227], v[192:195]
    s_waitcnt lgkmcnt(1)
    v_mfma_f32_16x16x32_bf16 v[152:155], v[120:123], v[80:83], v[152:155]
    v_fmac_f32 v179, s25, v147
    v_fmac_f32 v187, s24, v139
    v_mfma_f32_16x16x32_bf16 v[156:159], v[120:123], v[84:87], v[156:159]
    v_mul_f32 v188, s23, v148
    v_mul_f32 v189, s23, v149
    v_mfma_f32_16x16x32_bf16 v[160:163], v[120:123], v[88:91], v[160:163]
    v_mul_f32 v190, s23, v150
    v_mul_f32 v191, s23, v151
    v_mfma_f32_16x16x32_bf16 v[164:167], v[120:123], v[92:95], v[164:167]
    v_fmac_f32_dpp v188, v148, v12 row_ror:8 row_mask:0xf bank_mask:0xf
    v_fmac_f32_dpp v189, v149, v12 row_ror:8 row_mask:0xf bank_mask:0xf
    v_mfma_f32_16x16x32_bf16 v[168:171], v[120:123], v[96:99], v[168:171]
    v_fmac_f32_dpp v190, v150, v12 row_ror:8 row_mask:0xf bank_mask:0xf
    v_fmac_f32_dpp v191, v151, v12 row_ror:8 row_mask:0xf bank_mask:0xf
    v_mfma_f32_16x16x32_bf16 v[196:199], v[120:123], v[120:123], v[196:199]
    v_mfma_f32_16x16x32_bf16 v[192:195], v[120:123], v[224:227], v[192:195]
    s_waitcnt lgkmcnt(0)
    v_mfma_f32_16x16x32_bf16 v[196:199], v[124:127], v[124:127], v[196:199]
    v_mfma_f32_16x16x32_bf16 v[192:195], v[124:127], v[224:227], v[192:195]
    v_mfma_f32_16x16x32_bf16 v[152:155], v[124:127], v[100:103], v[152:155]
    v_mfma_f32_16x16x32_bf16 v[156:159], v[124:127], v[104:107], v[156:159]
    s_lshl_b32 s27, s3, 5
    s_add_u32 s27, s27, 107520
    v_lshl_add_u32 v6, v2, 3, s27
    v_mul_u32_u24 v7, 144, v1
    v_add_u32 v7, v6, v7
    v_and_b32 v8, 7, v1
    v_cndmask_b32 v14, 0, v196, s[36:37]
    v_cndmask_b32 v14, v14, v197, s[38:39]
    v_cndmask_b32 v14, v14, v198, s[40:41]
    v_cndmask_b32 v14, v14, v199, s[42:43]
    v_mul_u32_u24 v8, 144, v8
    v_lshrrev_b32 v9, 3, v1
    v_mfma_f32_16x16x4_f32 v[196:199], v14, v18, 0
    v_mul_u32_u24 v9, 6912, v9
    v_add3_u32 v6, v6, v8, v9
    v_mfma_f32_16x16x32_bf16 v[160:163], v[124:127], v[108:111], v[160:163]
    v_mul_f32 v192, 0x3acccccd, v192
    v_mul_f32 v193, 0x3acccccd, v193
    v_mul_f32 v194, 0x3acccccd, v194
    v_mul_f32 v195, 0x3acccccd, v195
    v_mfma_f32_16x16x32_bf16 v[164:167], v[124:127], v[112:115], v[164:167]
    v_mfma_f32_16x16x32_bf16 v[168:171], v[124:127], v[116:119], v[168:171]
    s_nop 3
    v_mul_f32 v196, 0x3acccccd, v196
    v_mul_f32 v197, 0x3acccccd, v197
    v_mul_f32 v198, 0x3acccccd, v198
    v_mul_f32 v199, 0x3acccccd, v199
    v_fma_f32 v192, -v192, v192, v196
    v_fma_f32 v193, -v193, v193, v197
    v_fma_f32 v194, -v194, v194, v198
    v_fma_f32 v195, -v195, v195, v199
    v_max_f32 v192, 0, v192
    v_max_f32 v193, 0, v193
    v_max_f32 v194, 0, v194
    v_max_f32 v195, 0, v195
    v_cvt_pk_bf16_f32 v228, v192, v193
    v_cvt_pk_bf16_f32 v229, v194, v195
    v_lshlrev_b32 v192, 16, v228
    v_and_b32 v193, 0xffff0000, v228
    v_lshlrev_b32 v194, 16, v229
    v_and_b32 v195, 0xffff0000, v229
    v_add_f32 v192, 0x3727c5ac, v192
    v_add_f32 v193, 0x3727c5ac, v193
    v_add_f32 v194, 0x3727c5ac, v194
    v_add_f32 v195, 0x3727c5ac, v195
    v_cvt_pk_bf16_f32 v228, v192, v193
    v_cvt_pk_bf16_f32 v229, v194, v195
    v_lshlrev_b32 v192, 16, v228
    v_and_b32 v193, 0xffff0000, v228
    v_lshlrev_b32 v194, 16, v229
    v_and_b32 v195, 0xffff0000, v229
    v_sqrt_f32 v192, v192
    v_sqrt_f32 v193, v193
    v_sqrt_f32 v194, v194
    v_sqrt_f32 v195, v195
    v_add_f32 v152, v152, v172
    v_add_f32 v153, v153, v173
    v_add_f32 v154, v154, v174
    v_add_f32 v155, v155, v175
    v_cvt_pk_bf16_f32 v228, v192, v193
    v_cvt_pk_bf16_f32 v229, v194, v195
    v_lshlrev_b32 v192, 16, v228
    v_and_b32 v193, 0xffff0000, v228
    v_lshlrev_b32 v194, 16, v229
    v_and_b32 v195, 0xffff0000, v229
    v_rcp_f32 v192, v192
    v_rcp_f32 v193, v193
    v_rcp_f32 v194, v194
    v_rcp_f32 v195, v195
    v_add_f32 v156, v156, v176
    v_add_f32 v157, v157, v177
    v_add_f32 v158, v158, v178
    v_add_f32 v159, v159, v179
    v_add_f32 v160, v160, v180
    v_add_f32 v161, v161, v181
    v_add_f32 v162, v162, v182
    v_add_f32 v163, v163, v183
    v_add_f32 v164, v164, v184
    v_add_f32 v165, v165, v185
    v_add_f32 v166, v166, v186
    v_add_f32 v167, v167, v187
    v_add_f32 v168, v168, v188
    v_add_f32 v169, v169, v189
    v_add_f32 v170, v170, v190
    v_add_f32 v171, v171, v191
    v_mul_f32 v152, v152, v192
    v_mul_f32 v153, v153, v193
    v_mul_f32 v154, v154, v194
    v_mul_f32 v155, v155, v195
    v_cvt_pk_bf16_f32 v172, v152, v153
    v_cvt_pk_bf16_f32 v173, v154, v155
    ds_write_b64 v7, v[172:173] offset:0
    v_mul_f32 v156, v156, v192
    v_mul_f32 v157, v157, v193
    v_mul_f32 v158, v158, v194
    v_mul_f32 v159, v159, v195
    v_cvt_pk_bf16_f32 v176, v156, v157
    v_cvt_pk_bf16_f32 v177, v158, v159
    ds_write_b64 v7, v[176:177] offset:2304
    v_mul_f32 v160, v160, v192
    v_mul_f32 v161, v161, v193
    v_mul_f32 v162, v162, v194
    v_mul_f32 v163, v163, v195
    v_cvt_pk_bf16_f32 v180, v160, v161
    v_cvt_pk_bf16_f32 v181, v162, v163
    ds_write_b64 v7, v[180:181] offset:6912
    v_mul_f32 v164, v164, v192
    v_mul_f32 v165, v165, v193
    v_mul_f32 v166, v166, v194
    v_mul_f32 v167, v167, v195
    v_cvt_pk_bf16_f32 v184, v164, v165
    v_cvt_pk_bf16_f32 v185, v166, v167
    ds_write_b64 v7, v[184:185] offset:9216
    v_mul_f32 v168, v168, v192
    v_mul_f32 v169, v169, v193
    v_mul_f32 v170, v170, v194
    v_mul_f32 v171, v171, v195
    v_cvt_pk_bf16_f32 v188, v168, v169
    v_cvt_pk_bf16_f32 v189, v170, v171
    ds_write_b64 v6, v[188:189] offset:4608
    v_mul_u32_u24 v7, 144, v1
    v_lshl_add_u32 v7, v2, 4, v7
    v_add_u32 v7, 107520, v7
    v_lshl_add_u32 v8, v2, 2, s16
    v_mul_lo_u32 v8, v8, s17
    s_mul_i32 s18, s12, 1280
    s_mul_i32 s19, s13, 160
    s_add_u32 s18, s18, s19
    s_andn2_b32 s18, s18, 63
    s_and_b32 s21, s13, 1
    s_mul_i32 s19, s21, 1152
    v_subrev_u32 v7, s19, v7
    v_lshl_add_u32 v8, v1, 2, v8
    v_add_u32 v8, s18, v8
    v_bfrev_b32 v9, 1
    s_cmp_eq_u32 s21, 1
    s_cselect_b64 s[36:37], -1, vcc
    s_cselect_b64 s[38:39], vcc, 0
    v_cndmask_b32 v10, v8, v9, s[38:39]
    v_cndmask_b32 v9, v9, v8, s[36:37]
    s_mov_b32 s18, 81920
    s_mov_b32 s19, 122880
    s_waitcnt lgkmcnt(0)
    s_barrier
    ds_read_b128 v[20:23], v7 offset:0
    ds_read_b128 v[24:27], v7 offset:64
    ds_read_b128 v[28:31], v7 offset:6912
    ds_read_b128 v[32:35], v7 offset:6976
    ds_read_b128 v[36:39], v7 offset:2304
    ds_read_b128 v[40:43], v7 offset:2368
    ds_read_b128 v[44:47], v7 offset:9216
    ds_read_b128 v[48:51], v7 offset:9280
    ds_read_b128 v[52:55], v7 offset:4608
    ds_read_b128 v[56:59], v7 offset:4672
    ds_read_b128 v[60:63], v7 offset:11520
    ds_read_b128 v[64:67], v7 offset:11584
    s_waitcnt lgkmcnt(10)
    v_mfma_f32_16x16x32_bf16 v[70:73], v[200:203], v[20:23], 0
    v_mfma_f32_16x16x32_bf16 v[74:77], v[208:211], v[20:23], 0
    v_mfma_f32_16x16x32_bf16 v[70:73], v[204:207], v[24:27], v[70:73]
    v_mfma_f32_16x16x32_bf16 v[74:77], v[212:215], v[24:27], v[74:77]
    s_waitcnt lgkmcnt(8)
    v_mfma_f32_16x16x32_bf16 v[70:73], v[216:219], v[28:31], v[70:73]
    v_mfma_f32_16x16x32_bf16 v[74:77], v[200:203], v[28:31], v[74:77]
    v_mfma_f32_16x16x32_bf16 v[70:73], v[220:223], v[32:35], v[70:73]
    v_mfma_f32_16x16x32_bf16 v[74:77], v[204:207], v[32:35], v[74:77]
    s_waitcnt lgkmcnt(6)
    v_mfma_f32_16x16x32_bf16 v[78:81], v[200:203], v[36:39], 0
    v_mfma_f32_16x16x32_bf16 v[82:85], v[208:211], v[36:39], 0
    v_mfma_f32_16x16x32_bf16 v[78:81], v[204:207], v[40:43], v[78:81]
    v_mfma_f32_16x16x32_bf16 v[82:85], v[212:215], v[40:43], v[82:85]
    s_waitcnt lgkmcnt(4)
    v_mfma_f32_16x16x32_bf16 v[78:81], v[216:219], v[44:47], v[78:81]
    v_mfma_f32_16x16x32_bf16 v[82:85], v[200:203], v[44:47], v[82:85]
    v_mfma_f32_16x16x32_bf16 v[78:81], v[220:223], v[48:51], v[78:81]
    v_mfma_f32_16x16x32_bf16 v[82:85], v[204:207], v[48:51], v[82:85]
    v_cvt_pk_bf16_f32 v100, v70, v74
    buffer_store_dword v100, v10, s[8:11], 0 offen offset:0 sc1
    v_cvt_pk_bf16_f32 v101, v71, v75
    buffer_store_dword v101, v10, s[8:11], s17 offen offset:0 sc1
    v_cvt_pk_bf16_f32 v102, v72, v76
    buffer_store_dword v102, v10, s[8:11], s18 offen offset:0 sc1
    v_cvt_pk_bf16_f32 v103, v73, v77
    buffer_store_dword v103, v10, s[8:11], s19 offen offset:0 sc1
    s_waitcnt lgkmcnt(2)
    v_mfma_f32_16x16x32_bf16 v[86:89], v[200:203], v[52:55], 0
    v_mfma_f32_16x16x32_bf16 v[90:93], v[208:211], v[52:55], 0
    v_mfma_f32_16x16x32_bf16 v[86:89], v[204:207], v[56:59], v[86:89]
    v_mfma_f32_16x16x32_bf16 v[90:93], v[212:215], v[56:59], v[90:93]
    s_waitcnt lgkmcnt(0)
    v_mfma_f32_16x16x32_bf16 v[86:89], v[216:219], v[60:63], v[86:89]
    v_mfma_f32_16x16x32_bf16 v[90:93], v[200:203], v[60:63], v[90:93]
    v_mfma_f32_16x16x32_bf16 v[86:89], v[220:223], v[64:67], v[86:89]
    v_mfma_f32_16x16x32_bf16 v[90:93], v[204:207], v[64:67], v[90:93]
    v_cvt_pk_bf16_f32 v104, v78, v82
    buffer_store_dword v104, v8, s[8:11], 0 offen offset:64 sc1
    v_cvt_pk_bf16_f32 v105, v79, v83
    buffer_store_dword v105, v8, s[8:11], s17 offen offset:64 sc1
    v_cvt_pk_bf16_f32 v106, v80, v84
    buffer_store_dword v106, v8, s[8:11], s18 offen offset:64 sc1
    v_cvt_pk_bf16_f32 v107, v81, v85
    buffer_store_dword v107, v8, s[8:11], s19 offen offset:64 sc1
    s_nop 7
    v_cvt_pk_bf16_f32 v108, v86, v90
    buffer_store_dword v108, v9, s[8:11], 0 offen offset:128 sc1
    v_cvt_pk_bf16_f32 v109, v87, v91
    buffer_store_dword v109, v9, s[8:11], s17 offen offset:128 sc1
    v_cvt_pk_bf16_f32 v110, v88, v92
    buffer_store_dword v110, v9, s[8:11], s18 offen offset:128 sc1
    v_cvt_pk_bf16_f32 v111, v89, v93
    buffer_store_dword v111, v9, s[8:11], s19 offen offset:128 sc1
k2_pre:
    s_lshr_b32 s14, s3, 2
    s_and_b32 s15, s3, 3
    s_sub_u32 s16, 64, s12
    s_cmp_eq_u32 s12, 0
    s_cselect_b32 s16, 32, s16
    s_cmp_eq_u32 s14, 0
    s_cselect_b32 s16, s12, s16
    s_mul_i32 s17, s16, 40960
    v_mul_u32_u24 v3, 1280, v2
    v_lshl_add_u32 v3, v1, 4, v3
    s_lshl_b32 s18, s15, 8
    s_add_u32 s18, s18, s17
    s_cmp_eq_u32 s3, 0
    s_cselect_b32 s19, 1, 0
    s_cmp_eq_u32 s3, 5
    s_cselect_b32 s19, 1, s19
    v_lshrrev_b32 v6, 2, v1
    s_lshl_b32 s20, s14, 2
    s_cmp_eq_u32 s12, 0
    s_cbranch_scc1 k2_u0
    s_lshl_b32 s21, s13, 2
    v_add_u32 v4, s21, v6
    s_mul_i32 s21, s14, 31
    v_xor_b32 v4, s21, v4
    s_xor_b32 s21, s20, 4
    v_add_u32 v5, s21, v2
    s_branch k2_t2done
k2_u0:
    v_lshrrev_b32 v4, 1, v6
    s_lshl_b32 s21, s13, 1
    v_add_u32 v4, s21, v4
    s_sub_u32 s21, 32, s14
    v_sub_u32 v7, s21, v4
    v_and_b32 v6, 1, v6
    v_cmp_eq_u32 vcc, 1, v6
    v_xor_b32 v5, 1, v2
    s_or_b32 s21, s13, s14
    v_cndmask_b32 v4, v4, v7, vcc
    v_cmp_eq_u32 vcc, 32, v4
    s_cmp_eq_u32 s21, 0
    s_cselect_b32 s21, 2, 0
    v_cndmask_b32 v4, v4, 16, vcc
    v_cmp_gt_u32 vcc, s21, v2
    s_nop 1
    v_cndmask_b32 v5, v5, v2, vcc
    v_add_u32 v5, s20, v5
k2_t2done:
    s_lshl_b32 s21, s15, 2
    s_nop 0
    v_readlane_b32 s22, v4, s21
    v_cvt_f32_u32 v6, v4
    v_cvt_f32_u32 v7, v2
    s_lshl_b32 s22, s22, 6
    s_add_u32 s22, s22, s16
    s_mul_i32 s23, s22, 1280
    v_lshlrev_b32 v28, 4, v0
    v_lshlrev_b32 v29, 2, v0
    v_mul_f32 v6, 0x3d000000, v6
    buffer_load_dwordx4 v[100:103], v28, s[4:7], s23 offen
    buffer_load_dword v104, v29, s[4:7], s23 offen offset:1024
    buffer_load_dwordx4 v[108:111], v28, s[28:31], 0 offen
    buffer_load_dword v112, v29, s[28:31], 0 offen offset:1024
    s_cmp_ge_u32 s3, 4
    s_cbranch_scc1 k_h2
k2_join:
    s_lshl_b32 s20, s14, 2
    v_mul_f32 v7, v6, v7
    v_mul_f32 v6, 4.0, v6
    v_and_b32 v10, 3, v1
    v_cmp_eq_u32 s[36:37], 0, v10
    s_nop 1
    v_cndmask_b32 v12, 0, -1, s[36:37]
    v_cmp_eq_u32 s[38:39], 1, v10
    s_nop 1
    v_cndmask_b32 v13, 0, -1, s[38:39]
    v_cmp_eq_u32 s[36:37], 2, v10
    s_nop 1
    v_cndmask_b32 v14, 0, -1, s[36:37]
    v_cmp_eq_u32 s[38:39], 3, v10
    s_nop 1
    v_cndmask_b32 v15, 0, -1, s[38:39]
    v_cos_f32 v10, v7
    v_sin_f32 v11, v7
    v_add_f32 v7, v7, v6
    v_cvt_pk_bf16_f32 v10, v10, v11
    v_and_b32 v128, v12, v10
    v_and_b32 v129, v13, v10
    v_and_b32 v130, v14, v10
    v_and_b32 v131, v15, v10
    v_cos_f32 v10, v7
    v_sin_f32 v11, v7
    v_add_f32 v7, v7, v6
    v_cvt_pk_bf16_f32 v10, v10, v11
    v_and_b32 v132, v12, v10
    v_and_b32 v133, v13, v10
    v_and_b32 v134, v14, v10
    v_and_b32 v135, v15, v10
    v_cos_f32 v10, v7
    v_sin_f32 v11, v7
    v_add_f32 v7, v7, v6
    v_cvt_pk_bf16_f32 v10, v10, v11
    v_and_b32 v136, v12, v10
    v_and_b32 v137, v13, v10
    v_and_b32 v138, v14, v10
    v_and_b32 v139, v15, v10
    v_cos_f32 v10, v7
    v_sin_f32 v11, v7
    v_add_f32 v7, v7, v6
    v_cvt_pk_bf16_f32 v10, v10, v11
    v_and_b32 v140, v12, v10
    v_and_b32 v141, v13, v10
    v_and_b32 v142, v14, v10
    v_and_b32 v143, v15, v10
    v_cos_f32 v10, v7
    v_sin_f32 v11, v7
    v_add_f32 v7, v7, v6
    v_cvt_pk_bf16_f32 v10, v10, v11
    v_and_b32 v144, v12, v10
    v_and_b32 v145, v13, v10
    v_and_b32 v146, v14, v10
    v_and_b32 v147, v15, v10
    v_cos_f32 v10, v7
    v_sin_f32 v11, v7
    v_add_f32 v7, v7, v6
    v_cvt_pk_bf16_f32 v10, v10, v11
    v_and_b32 v148, v12, v10
    v_and_b32 v149, v13, v10
    v_and_b32 v150, v14, v10
    v_and_b32 v151, v15, v10
    v_cos_f32 v10, v7
    v_sin_f32 v11, v7
    v_add_f32 v7, v7, v6
    v_cvt_pk_bf16_f32 v10, v10, v11
    v_and_b32 v152, v12, v10
    v_and_b32 v153, v13, v10
    v_and_b32 v154, v14, v10
    v_and_b32 v155, v15, v10
    v_cos_f32 v10, v7
    v_sin_f32 v11, v7
    v_add_f32 v7, v7, v6
    v_cvt_pk_bf16_f32 v10, v10, v11
    v_and_b32 v156, v12, v10
    v_and_b32 v157, v13, v10
    v_and_b32 v158, v14, v10
    v_and_b32 v159, v15, v10
    v_add_u32 v18, s20, v2
    v_mul_u32_u24 v18, 2592, v18
    v_mul_u32_u24 v19, 2592, v5
    v_add_u32 v19, 2080, v19
    s_lshl_b32 s21, s15, 4
    s_mul_i32 s24, s3, 2592
    v_mov_b32 v26, s24
    v_mov_b32 v27, 0
    v_add_u32 v10, s21, v1
    v_mul_u32_u24 v11, 205, v10
    v_lshrrev_b32 v11, 11, v11
    v_mul_u32_u24 v16, 10, v11
    v_sub_u32 v16, v10, v16
    v_lshrrev_b32 v17, 2, v11
    v_mul_u32_u24 v17, 160, v17
    v_and_b32 v11, 3, v11
    v_add3_u32 v11, v11, v17, 1
    v_lshl_add_u32 v11, v16, 2, v11
    v_lshlrev_b32 v11, 2, v11
    v_add_u32 v20, v18, v11
    v_sub_u32 v21, v19, v11
    v_add_u32 v10, 64, v1
    v_mul_u32_u24 v11, 205, v10
    v_lshrrev_b32 v11, 11, v11
    v_mul_u32_u24 v16, 10, v11
    v_sub_u32 v16, v10, v16
    v_lshrrev_b32 v17, 2, v11
    v_mul_u32_u24 v17, 160, v17
    v_and_b32 v11, 3, v11
    v_add3_u32 v11, v11, v17, 1
    v_lshl_add_u32 v11, v16, 2, v11
    v_lshlrev_b32 v11, 2, v11
    v_add_u32 v22, v18, v11
    v_sub_u32 v23, v19, v11
    v_cmp_eq_u32 vcc, 15, v1
    v_add_u32 v24, 480, v19
    s_nop 0
    v_cndmask_b32 v24, v23, v24, vcc
    s_mov_b32 s25, 0xffff0000
    s_mov_b32 s26, 0x3f803f80
    s_cmp_lt_u32 s3, 4
    s_cselect_b32 s40, s52, s54
    s_cselect_b32 s41, s53, s55
    s_and_b32 s36, s2, 7
    s_lshr_b32 s37, s2, 3
    s_mul_i32 s48, s36, 6
    s_add_u32 s48, s48, s37
    s_lshl_b32 s39, s48, 6
    s_movk_i32 s49, 3072
    s_mul_i32 s38, s15, 491520
    s_mul_i32 s27, s3, 10240
    s_movk_i32 s60, 5
    s_cmp_lt_u32 s2, 48
    s_cbranch_scc1 k2_wg
    s_mov_b32 s40, s56
    s_mov_b32 s41, s57
    s_mul_i32 s48, s36, 5
    s_add_u32 s48, s48, s37
    s_sub_u32 s48, s48, 6
    s_lshr_b32 s39, s48, 1
    s_lshl_b32 s39, s39, 6
    s_movk_i32 s49, 1280
    s_mul_i32 s38, s3, 245760
    s_mul_i32 s27, s3, 12288
    s_movk_i32 s60, 12
k2_wg:
    s_add_u32 s61, s38, s39
    v_lshrrev_b32 v6, 2, v0
    v_mul_lo_u32 v6, v6, s49
    v_lshrrev_b32 v7, 4, v0
    v_and_b32 v7, 2, v7
    v_xor_b32 v7, v7, v0
    v_and_b32 v7, 3, v7
    v_lshl_add_u32 v114, v7, 4, v6
    s_lshl_b32 s49, s49, 4
    s_add_u32 m0, s27, 32768
    s_mov_b32 s42, 1966080
    s_mov_b32 s43, 0x00020000
    s_lshl_b32 s37, s2, 6
    s_add_u32 s37, s37, 2621440
    s_lshl_b32 s36, s3, 13
    s_add_u32 s36, s36, 2588672
    s_add_u32 s39, s36, 4096
    v_lshlrev_b32 v30, 6, v0
    ds_write_b32 v26, v27
    s_cmp_ge_u32 s3, 6
    s_cbranch_scc1 k2_nowait
    s_cmp_lg_u32 s3, 4
    s_cbranch_scc1 k2_go_ok
k2_go:
    buffer_load_dword v31, v29, s[44:47], 0 offen sc1
    s_waitcnt vmcnt(0)
    v_cmp_eq_u32 vcc, 0, v31
    s_cbranch_vccz k2_go_ok
    s_add_u32 s50, s50, 1
    s_cmp_lt_u32 s50, 32768
    s_cbranch_scc1 k2_go
k2_go_ok:
    s_waitcnt vmcnt(0)
k2_nowait:
    s_barrier
    s_cmp_lg_u32 s3, 0
    s_cbranch_scc1 k2_nf
    s_mov_b64 exec, 1
    buffer_store_dword v27, v27, s[8:11], s37 offen sc1
    s_mov_b64 exec, -1
k2_nf:
    s_barrier
    s_and_b32 s21, s3, 6
    s_cmp_lg_u32 s21, 4
    s_cbranch_scc1 k2_s1_ok
    buffer_load_dword v32, v30, s[8:11], s36 offen sc1
    buffer_load_dword v33, v30, s[8:11], s39 offen sc1
k2_s1:
    buffer_load_dword v34, v30, s[8:11], s36 offen sc1
    buffer_load_dword v35, v30, s[8:11], s39 offen sc1
    s_waitcnt vmcnt(2)
    v_or_b32 v31, v32, v33
    v_cmp_ne_u32 vcc, 0, v31
    s_cbranch_vccz k2_s1_ok
    buffer_load_dword v32, v30, s[8:11], s36 offen sc1
    buffer_load_dword v33, v30, s[8:11], s39 offen sc1
    s_waitcnt vmcnt(2)
    v_or_b32 v31, v34, v35
    v_cmp_ne_u32 vcc, 0, v31
    s_cbranch_vccz k2_s1_ok
    s_add_u32 s50, s50, 1
    s_cmp_lt_u32 s50, 32768
    s_cbranch_scc1 k2_s1
k2_s1_ok:
    s_barrier
    s_cmp_eq_u32 s19, 0
    s_cbranch_scc1 k2_one
    s_mov_b32 s21, s18
    s_add_u32 s18, s17, 1024
    buffer_load_dwordx4 v[64:67], v3, s[8:11], s18 offen
    s_addk_i32 s18, 5120
    buffer_load_dwordx4 v[68:71], v3, s[8:11], s18 offen
    s_addk_i32 s18, 5120
    buffer_load_dwordx4 v[72:75], v3, s[8:11], s18 offen
    s_addk_i32 s18, 5120
    buffer_load_dwordx4 v[76:79], v3, s[8:11], s18 offen
    s_addk_i32 s18, 5120
    buffer_load_dwordx4 v[80:83], v3, s[8:11], s18 offen
    s_addk_i32 s18, 5120
    buffer_load_dwordx4 v[84:87], v3, s[8:11], s18 offen
    s_addk_i32 s18, 5120
    buffer_load_dwordx4 v[88:91], v3, s[8:11], s18 offen
    s_addk_i32 s18, 5120
    buffer_load_dwordx4 v[92:95], v3, s[8:11], s18 offen
    s_mov_b32 s18, s21
    buffer_load_dwordx4 v[32:35], v3, s[8:11], s18 offen
    s_addk_i32 s18, 5120
    buffer_load_dwordx4 v[36:39], v3, s[8:11], s18 offen
    s_addk_i32 s18, 5120
    buffer_load_dwordx4 v[40:43], v3, s[8:11], s18 offen
    s_addk_i32 s18, 5120
    buffer_load_dwordx4 v[44:47], v3, s[8:11], s18 offen
    s_addk_i32 s18, 5120
    buffer_load_dwordx4 v[48:51], v3, s[8:11], s18 offen
    s_addk_i32 s18, 5120
    buffer_load_dwordx4 v[52:55], v3, s[8:11], s18 offen
    s_addk_i32 s18, 5120
    buffer_load_dwordx4 v[56:59], v3, s[8:11], s18 offen
    s_addk_i32 s18, 5120
    buffer_load_dwordx4 v[60:63], v3, s[8:11], s18 offen
    s_waitcnt vmcnt(15)
    v_mfma_f32_16x16x32_bf16 v[164:167], v[128:131], v[64:67], 0
    s_waitcnt vmcnt(14)
    v_mfma_f32_16x16x32_bf16 v[164:167], v[132:135], v[68:71], v[164:167]
    s_waitcnt vmcnt(13)
    v_mfma_f32_16x16x32_bf16 v[164:167], v[136:139], v[72:75], v[164:167]
    s_waitcnt vmcnt(12)
    v_mfma_f32_16x16x32_bf16 v[164:167], v[140:143], v[76:79], v[164:167]
    s_waitcnt vmcnt(11)
    v_mfma_f32_16x16x32_bf16 v[164:167], v[144:147], v[80:83], v[164:167]
    s_waitcnt vmcnt(10)
    v_mfma_f32_16x16x32_bf16 v[164:167], v[148:151], v[84:87], v[164:167]
    s_waitcnt vmcnt(9)
    v_mfma_f32_16x16x32_bf16 v[164:167], v[152:155], v[88:91], v[164:167]
    s_waitcnt vmcnt(8)
    v_mfma_f32_16x16x32_bf16 v[164:167], v[156:159], v[92:95], v[164:167]
    s_nop 7
    ds_write_b32 v22, v164 offset:0
    ds_write_b32 v22, v165 offset:160
    ds_write_b32 v22, v166 offset:320
    ds_write_b32 v22, v167 offset:480
    ds_write_b32 v23, v164 offset:480
    ds_write_b32 v23, v165 offset:320
    ds_write_b32 v23, v166 offset:160
    ds_write_b32 v24, v167 offset:0
    s_branch k2_two
k2_one:
    buffer_load_dwordx4 v[32:35], v3, s[8:11], s18 offen
    s_addk_i32 s18, 5120
    buffer_load_dwordx4 v[36:39], v3, s[8:11], s18 offen
    s_addk_i32 s18, 5120
    buffer_load_dwordx4 v[40:43], v3, s[8:11], s18 offen
    s_addk_i32 s18, 5120
    buffer_load_dwordx4 v[44:47], v3, s[8:11], s18 offen
    s_addk_i32 s18, 5120
    buffer_load_dwordx4 v[48:51], v3, s[8:11], s18 offen
    s_addk_i32 s18, 5120
    buffer_load_dwordx4 v[52:55], v3, s[8:11], s18 offen
    s_addk_i32 s18, 5120
    buffer_load_dwordx4 v[56:59], v3, s[8:11], s18 offen
    s_addk_i32 s18, 5120
    buffer_load_dwordx4 v[60:63], v3, s[8:11], s18 offen
k2_two:
    s_waitcnt vmcnt(7)
    v_mfma_f32_16x16x32_bf16 v[160:163], v[128:131], v[32:35], 0
    s_waitcnt vmcnt(6)
    v_mfma_f32_16x16x32_bf16 v[160:163], v[132:135], v[36:39], v[160:163]
    s_waitcnt vmcnt(5)
    v_mfma_f32_16x16x32_bf16 v[160:163], v[136:139], v[40:43], v[160:163]
    s_waitcnt vmcnt(4)
    v_mfma_f32_16x16x32_bf16 v[160:163], v[140:143], v[44:47], v[160:163]
    s_waitcnt vmcnt(3)
    v_mfma_f32_16x16x32_bf16 v[160:163], v[144:147], v[48:51], v[160:163]
    s_waitcnt vmcnt(2)
    v_mfma_f32_16x16x32_bf16 v[160:163], v[148:151], v[52:55], v[160:163]
    s_waitcnt vmcnt(1)
    v_mfma_f32_16x16x32_bf16 v[160:163], v[152:155], v[56:59], v[160:163]
    s_waitcnt vmcnt(0)
    v_mfma_f32_16x16x32_bf16 v[160:163], v[156:159], v[60:63], v[160:163]
    v_lshl_add_u32 v10, v0, 5, s24
    v_lshl_add_u32 v11, v0, 3, s24
    v_mov_b32 v12, 0
    v_mov_b32 v13, 0
    v_mov_b32 v14, 0
    s_lshl_b32 s37, s3, 2
    v_mov_b32 v15, s37
    v_mov_b32 v16, 0x3acccccd
    ds_write_b32 v20, v160 offset:0
    ds_write_b32 v20, v161 offset:160
    ds_write_b32 v20, v162 offset:320
    ds_write_b32 v20, v163 offset:480
    ds_write_b32 v21, v160 offset:480
    ds_write_b32 v21, v161 offset:320
    ds_write_b32 v21, v162 offset:160
    ds_write_b32 v21, v163 offset:0
    v_lshlrev_b32 v48, 16, v100
    v_and_b32 v49, s25, v100
    v_lshlrev_b32 v50, 16, v101
    v_and_b32 v51, s25, v101
    v_lshlrev_b32 v52, 16, v102
    v_and_b32 v53, s25, v102
    v_lshlrev_b32 v54, 16, v103
    v_and_b32 v55, s25, v103
    v_lshlrev_b32 v56, 16, v104
    v_and_b32 v57, s25, v104
    s_waitcnt lgkmcnt(0)
    s_barrier
    ds_read_b128 v[32:35], v10
    ds_read_b128 v[36:39], v10 offset:16
    ds_read_b64 v[40:41], v11 offset:2048
    s_cmp_ge_u32 s2, 48
    s_cbranch_scc1 k2_e0
    buffer_load_dwordx4 v114, s[40:43], s61 offen lds
    s_addk_i32 m0, 1024
    s_add_u32 s61, s61, s49
k2_e0:
    s_waitcnt lgkmcnt(2)
    v_pk_add_f32 v[32:33], v[32:33], v[48:49]
    v_pk_add_f32 v[34:35], v[34:35], v[50:51]
    s_waitcnt lgkmcnt(1)
    v_pk_add_f32 v[36:37], v[36:37], v[52:53]
    v_pk_add_f32 v[38:39], v[38:39], v[54:55]
    s_waitcnt lgkmcnt(0)
    v_pk_add_f32 v[40:41], v[40:41], v[56:57]
    v_cvt_pk_bf16_f32 v60, v32, v33
    v_cvt_pk_bf16_f32 v61, v34, v35
    v_cvt_pk_bf16_f32 v62, v36, v37
    v_cvt_pk_bf16_f32 v63, v38, v39
    v_cvt_pk_bf16_f32 v64, v40, v41
    s_cmp_ge_u32 s2, 48
    s_cbranch_scc1 k2_e1
    buffer_load_dwordx4 v114, s[40:43], s61 offen lds
    s_addk_i32 m0, 1024
    s_add_u32 s61, s61, s49
k2_e1:
    v_dot2c_f32_bf16 v12, s26, v60
    v_dot2c_f32_bf16 v13, v60, v60
    v_dot2c_f32_bf16 v12, s26, v61
    v_dot2c_f32_bf16 v13, v61, v61
    v_dot2c_f32_bf16 v12, s26, v62
    v_dot2c_f32_bf16 v13, v62, v62
    v_dot2c_f32_bf16 v12, s26, v63
    v_dot2c_f32_bf16 v13, v63, v63
    v_dot2c_f32_bf16 v12, s26, v64
    v_dot2c_f32_bf16 v13, v64, v64
    v_lshlrev_b32 v48, 16, v60
    v_and_b32 v49, s25, v60
    s_nop 0
    v_add_f32_dpp v12, v12, v12 quad_perm:[1,0,3,2] row_mask:0xf bank_mask:0xf
    v_add_f32_dpp v13, v13, v13 quad_perm:[1,0,3,2] row_mask:0xf bank_mask:0xf
    v_lshlrev_b32 v50, 16, v61
    s_cmp_ge_u32 s2, 48
    s_cbranch_scc1 k2_e2
    buffer_load_dwordx4 v114, s[40:43], s61 offen lds
    s_addk_i32 m0, 1024
    s_add_u32 s61, s61, s49
k2_e2:
    v_add_f32_dpp v12, v12, v12 quad_perm:[2,3,0,1] row_mask:0xf bank_mask:0xf
    v_add_f32_dpp v13, v13, v13 quad_perm:[2,3,0,1] row_mask:0xf bank_mask:0xf
    v_and_b32 v51, s25, v61
    v_add_f32_dpp v12, v12, v12 row_half_mirror row_mask:0xf bank_mask:0xf
    v_add_f32_dpp v13, v13, v13 row_half_mirror row_mask:0xf bank_mask:0xf
    v_lshlrev_b32 v52, 16, v62
    v_add_f32_dpp v12, v12, v12 row_mirror row_mask:0xf bank_mask:0xf
    v_add_f32_dpp v13, v13, v13 row_mirror row_mask:0xf bank_mask:0xf
    v_and_b32 v53, s25, v62
    v_add_f32_dpp v12, v12, v12 row_bcast:15 row_mask:0xa bank_mask:0xf
    v_add_f32_dpp v13, v13, v13 row_bcast:15 row_mask:0xa bank_mask:0xf
    v_lshlrev_b32 v54, 16, v63
    v_add_f32_dpp v12, v12, v12 row_bcast:31 row_mask:0xc bank_mask:0xf
    v_add_f32_dpp v13, v13, v13 row_bcast:31 row_mask:0xc bank_mask:0xf
    v_and_b32 v55, s25, v63
    v_lshlrev_b32 v56, 16, v64
    v_readlane_b32 s36, v12, 63
    v_readlane_b32 s37, v13, 63
    v_and_b32 v57, s25, v64
    v_mul_f32 v12, s36, v16
    v_mul_f32 v13, s37, v16
    v_fma_f32 v13, -v12, v12, v13
    s_cmp_ge_u32 s2, 48
    s_cbranch_scc1 k2_e3
    buffer_load_dwordx4 v114, s[40:43], s61 offen lds
    s_addk_i32 m0, 1024
    s_add_u32 s61, s61, s49
k2_e3:
    v_max_f32 v13, 0, v13
    v_cvt_pk_bf16_f32 v13, v12, v13
    v_lshlrev_b32 v12, 16, v13
    v_and_b32 v13, s25, v13
    v_add_f32 v13, 0x3727c5ac, v13
    v_cvt_pk_bf16_f32 v13, v13, v13
    v_and_b32 v13, s25, v13
    v_sqrt_f32 v13, v13
    s_nop 0
    v_cvt_pk_bf16_f32 v13, v13, v13
    v_and_b32 v13, s25, v13
    v_rcp_f32 v13, v13
    s_nop 0
    v_mul_f32 v12, v12, v13
    v_pk_fma_f32 v[32:33], v[48:49], v[12:13], v[12:13] op_sel:[0,1,0] op_sel_hi:[1,1,0] neg_lo:[0,0,1] neg_hi:[0,0,1]
    v_pk_fma_f32 v[34:35], v[50:51], v[12:13], v[12:13] op_sel:[0,1,0] op_sel_hi:[1,1,0] neg_lo:[0,0,1] neg_hi:[0,0,1]
    v_pk_fma_f32 v[36:37], v[52:53], v[12:13], v[12:13] op_sel:[0,1,0] op_sel_hi:[1,1,0] neg_lo:[0,0,1] neg_hi:[0,0,1]
    v_pk_fma_f32 v[38:39], v[54:55], v[12:13], v[12:13] op_sel:[0,1,0] op_sel_hi:[1,1,0] neg_lo:[0,0,1] neg_hi:[0,0,1]
    v_pk_fma_f32 v[40:41], v[56:57], v[12:13], v[12:13] op_sel:[0,1,0] op_sel_hi:[1,1,0] neg_lo:[0,0,1] neg_hi:[0,0,1]
    v_cvt_pk_bf16_f32 v68, v32, v33
    s_cmp_ge_u32 s2, 48
    s_cbranch_scc1 k2_e4
    buffer_load_dwordx4 v114, s[40:43], s61 offen lds
    s_addk_i32 m0, 1024
    s_add_u32 s61, s61, s49
k2_e4:
    v_cvt_pk_bf16_f32 v69, v34, v35
    v_cvt_pk_bf16_f32 v70, v36, v37
    v_cvt_pk_bf16_f32 v71, v38, v39
    v_cvt_pk_bf16_f32 v72, v40, v41
    v_dot2c_f32_bf16 v14, v68, v108
    v_dot2c_f32_bf16 v14, v69, v109
    v_dot2c_f32_bf16 v14, v70, v110
    v_dot2c_f32_bf16 v14, v71, v111
    v_dot2c_f32_bf16 v14, v72, v112
    v_lshlrev_b32 v32, 16, v68
    v_and_b32 v33, s25, v68
    v_lshlrev_b32 v34, 16, v69
    v_add_f32_dpp v14, v14, v14 quad_perm:[1,0,3,2] row_mask:0xf bank_mask:0xf
    v_and_b32 v35, s25, v69
    v_lshlrev_b32 v36, 16, v70
    v_add_f32_dpp v14, v14, v14 quad_perm:[2,3,0,1] row_mask:0xf bank_mask:0xf
    v_and_b32 v37, s25, v70
    v_lshlrev_b32 v38, 16, v71
    v_add_f32_dpp v14, v14, v14 row_half_mirror row_mask:0xf bank_mask:0xf
    v_and_b32 v39, s25, v71
    v_lshlrev_b32 v40, 16, v72
    v_add_f32_dpp v14, v14, v14 row_mirror row_mask:0xf bank_mask:0xf
    v_and_b32 v41, s25, v72
    v_pk_add_f32 v[32:33], v[32:33], v[48:49]
    v_add_f32_dpp v14, v14, v14 row_bcast:15 row_mask:0xa bank_mask:0xf
    v_pk_add_f32 v[34:35], v[34:35], v[50:51]
    v_pk_add_f32 v[36:37], v[36:37], v[52:53]
    v_add_f32_dpp v14, v14, v14 row_bcast:31 row_mask:0xc bank_mask:0xf
    v_pk_add_f32 v[38:39], v[38:39], v[54:55]
    v_pk_add_f32 v[40:41], v[40:41], v[56:57]
    v_readlane_b32 s36, v14, 63
    s_nop 1
    v_cvt_pk_bf16_f32 v14, s36, s36
    v_ashrrev_i32 v16, 31, v14
    v_or_b32 v16, 0x80000000, v16
    v_xor_b32 v14, v14, v16
    v_and_b32 v14, s25, v14
    v_or_b32 v16, s3, v14
    ds_write_b32 v15, v16 offset:24576
    v_and_b32 v15, 28, v29
    v_cvt_pk_bf16_f32 v76, v32, v33
    v_cvt_pk_bf16_f32 v77, v34, v35
    v_cvt_pk_bf16_f32 v78, v36, v37
    v_cvt_pk_bf16_f32 v79, v38, v39
    v_cvt_pk_bf16_f32 v80, v40, v41
    v_min_u32 v68, -2, v68
    v_min_u32 v69, -2, v69
    v_min_u32 v70, -2, v70
    v_min_u32 v71, -2, v71
    v_min_u32 v72, -2, v72
    s_waitcnt lgkmcnt(0)
    s_barrier
    ds_read_b32 v15, v15 offset:24576
    v_mov_b32 v17, s22
    s_waitcnt lgkmcnt(0)
    v_cmp_gt_u32 vcc, v15, v16
    s_bcnt1_i32_b32 s36, vcc_lo
    s_lshr_b32 s36, s36, 2
    s_cmp_ge_u32 s36, 2
    s_cbranch_scc1 k2_plain
    s_lshl_b32 s37, s2, 1
    s_add_u32 s37, s36, s37
    v_or_b32 v14, s37, v14
    s_mul_i32 s37, s37, 3072
    s_add_u32 s37, s37, 3145728
    s_lshl_b32 s38, s2, 4
    s_add_u32 s36, s36, s38
    s_lshl_b32 s36, s36, 2
    s_add_u32 s36, s36, 2621448
    s_mov_b64 exec, 1
    buffer_store_dword v14, v27, s[8:11], s36 offen sc1
    s_mov_b64 exec, -1
    buffer_store_dwordx4 v[68:71], v28, s[8:11], s37 offen sc1
    buffer_store_dword v72, v29, s[8:11], s37 offen offset:1024 sc1
    v_min_u32 v60, -2, v60
    v_min_u32 v61, -2, v61
    v_min_u32 v62, -2, v62
    v_min_u32 v63, -2, v63
    v_min_u32 v64, -2, v64
    s_mov_b32 s51, s37
    s_movk_i32 s36, 6
    s_barrier
    buffer_store_dwordx4 v[76:79], v28, s[32:35], s23 offen sc1
    buffer_store_dword v80, v29, s[32:35], s23 offen offset:1024 sc1
    s_branch k2_wd
k2_plain:
    s_mov_b32 s51, -1
    s_barrier
    buffer_store_dwordx4 v[76:79], v28, s[32:35], s23 offen
    buffer_store_dword v80, v29, s[32:35], s23 offen offset:1024
k2_wd:
    s_cmp_ge_u32 s2, 48
    s_cbranch_scc1 k2_ng
k2_wd1:
    buffer_load_dwordx4 v114, s[40:43], s61 offen lds
    s_addk_i32 m0, 1024
    s_add_u32 s61, s61, s49
    s_sub_u32 s60, s60, 1
    s_cmp_lg_u32 s60, 0
    s_cbranch_scc1 k2_wd1
k2_ng:
    s_cmp_lt_u32 s2, 88
    s_cbranch_scc1 k2_nw
    s_movk_i32 s36, 6
    s_cmp_ge_u32 s3, 3
    s_cbranch_scc1 k2_s2
    s_lshr_b32 s37, s2, 3
    s_mul_i32 s37, s37, 74
    s_lshl_b32 s38, s3, 5
    s_add_u32 s37, s37, s38
    s_sub_u32 s37, s37, 814
    s_mul_i32 s37, s37, 1280
    s_and_b32 s38, s2, 7
    s_mul_i32 s38, s38, 5
    s_lshr_b32 s38, s38, 1
    s_lshl_b32 s38, s38, 6
    s_add_u32 s37, s37, s38
    v_lshrrev_b32 v4, 1, v0
    v_mul_u32_u24 v4, 1280, v4
    v_and_b32 v5, 1, v0
    v_lshl_add_u32 v4, v5, 7, v4
    buffer_load_dword v41, v4, s[40:43], s37 offen
k2_nw:
    s_cmp_ge_u32 s36, 6
    s_cbranch_scc1 k2_s2
    v_lshlrev_b32 v4, 6, v0
    s_lshl_b32 s24, s36, 12
    s_add_u32 s24, s24, 2613248
    s_lshl_b32 s36, s36, 3
    v_mov_b32 v5, s36
k2_s2p:
    buffer_load_dwordx2 v[8:9], v4, s[8:11], s24 offen offset:8 sc1
    s_waitcnt vmcnt(0)
    v_max_u32 v16, v8, v9
    v_cmp_eq_u32 vcc, -1, v16
    s_cbranch_vccz k2_s2p_ok
    s_add_u32 s50, s50, 1
    s_cmp_lt_u32 s50, 32768
    s_cbranch_scc1 k2_s2p
k2_s2p_ok:
    v_mov_b32 v19, v16
    v_min_u32 v17, v8, v9
    s_nop 1
    v_max_u32_dpp v19, v19, v19 quad_perm:[1,0,3,2] row_mask:0xf bank_mask:0xf
    s_nop 1
    v_max_u32_dpp v19, v19, v19 quad_perm:[2,3,0,1] row_mask:0xf bank_mask:0xf
    s_nop 1
    v_max_u32_dpp v19, v19, v19 row_half_mirror row_mask:0xf bank_mask:0xf
    s_nop 1
    v_max_u32_dpp v19, v19, v19 row_mirror row_mask:0xf bank_mask:0xf
    s_nop 1
    v_max_u32_dpp v19, v19, v19 row_bcast:15 row_mask:0xa bank_mask:0xf
    s_nop 1
    v_max_u32_dpp v19, v19, v19 row_bcast:31 row_mask:0xc bank_mask:0xf
    s_nop 0
    v_readlane_b32 s20, v19, 63
    s_nop 1
    v_cmp_eq_u32 vcc, s20, v16
    s_nop 1
    v_cndmask_b32 v18, v16, v17, vcc
    s_nop 1
    v_max_u32_dpp v18, v18, v18 quad_perm:[1,0,3,2] row_mask:0xf bank_mask:0xf
    s_nop 1
    v_max_u32_dpp v18, v18, v18 quad_perm:[2,3,0,1] row_mask:0xf bank_mask:0xf
    s_nop 1
    v_max_u32_dpp v18, v18, v18 row_half_mirror row_mask:0xf bank_mask:0xf
    s_nop 1
    v_max_u32_dpp v18, v18, v18 row_mirror row_mask:0xf bank_mask:0xf
    s_nop 1
    v_max_u32_dpp v18, v18, v18 row_bcast:15 row_mask:0xa bank_mask:0xf
    s_nop 1
    v_max_u32_dpp v18, v18, v18 row_bcast:31 row_mask:0xc bank_mask:0xf
    v_mov_b32 v16, s20
    v_readlane_b32 s21, v18, 63
    s_nop 1
    v_mov_b32 v17, s21
    ds_write_b64 v5, v[16:17] offset:24624
k2_s2:
    s_waitcnt vmcnt(0) lgkmcnt(0)
    s_cmp_eq_u32 s51, -1
    s_cbranch_scc1 k2_nt
    buffer_store_dwordx4 v[60:63], v28, s[8:11], s51 offen offset:1280 sc1
    buffer_store_dword v64, v29, s[8:11], s51 offen offset:2304 sc1
    s_mov_b64 exec, 1
    buffer_store_dword v17, v27, s[8:11], s51 offen offset:2560 sc1
    s_mov_b64 exec, -1
k2_nt:
    s_cmp_ge_u32 s2, 88
    s_cbranch_scc1 k_end
    s_barrier
    ds_read_b128 v[8:11], v27 offset:24640
    ds_read_b128 v[12:15], v27 offset:24656
    s_waitcnt lgkmcnt(0)
    v_min_u32 v16, v8, v10
    v_min_u32 v17, v12, v14
    v_max3_u32 v9, v9, v11, v16
    v_max3_u32 v13, v13, v15, v17
    v_max_u32 v8, v8, v10
    v_max_u32 v12, v12, v14
    v_min_u32 v16, v8, v12
    v_max3_u32 v17, v9, v13, v16
    v_max_u32 v16, v8, v12
    s_nop 0
    v_readfirstlane_b32 s21, v17
    v_readfirstlane_b32 s20, v16
    s_and_b32 s22, s20, 0x1ff
    s_and_b32 s23, s21, 0x1ff
    s_mul_i32 s22, s22, 3072
    s_mul_i32 s23, s23, 3072
    v_mov_b32 v16, s22
    v_mov_b32 v17, s23
    v_cmp_gt_u32 vcc, 8, v1
    s_mov_b32 s26, 3145728
    v_lshrrev_b32 v6, 2, v1
    v_lshl_add_u32 v6, v2, 3, v6
    v_lshlrev_b32 v6, 6, v6
    v_and_b32 v7, 3, v1
    v_lshl_add_u32 v6, v7, 3, v6
    s_cmp_ge_u32 s2, 48
    s_cbranch_scc1 k4
    s_cmp_lt_u32 s3, 4
    s_cselect_b32 s16, s22, s23
    s_cselect_b32 s17, 0, 1344
    s_mul_i32 s19, s15, 320
    s_add_u32 s16, s16, s19
    s_add_u32 s26, s26, s16
    v_min_u32 v5, 39, v0
    v_lshlrev_b32 v5, 3, v5
    s_add_u32 s17, s17, s19
    v_add_u32 v4, s17, v5
    s_bfe_u32 s16, s3, 0x10001
    s_mul_i32 s16, s16, 640
    v_lshrrev_b32 v10, 3, v1
    v_mul_u32_u24 v10, 1344, v10
    s_lshr_b32 s19, s3, 1
    s_mul_i32 s19, s19, 20480
    v_xor_b32 v7, s3, v2
    buffer_load_dwordx2 v[12:13], v5, s[8:11], s26 offen sc1
    v_and_b32 v7, 1, v7
    v_lshl_add_u32 v7, v7, 5, v6
    s_add_u32 s19, s19, 32768
    v_add_u32 v7, s19, v7
    v_lshl_add_u32 v10, v2, 4, v10
    v_add_u32 v10, s16, v10
    ds_read_b64_tr_b16 v[88:89], v7 offset:0
    ds_read_b64_tr_b16 v[90:91], v7 offset:256
    ds_read_b64_tr_b16 v[92:93], v7 offset:2048
    ds_read_b64_tr_b16 v[94:95], v7 offset:2304
    ds_read_b64_tr_b16 v[96:97], v7 offset:4096
    ds_read_b64_tr_b16 v[98:99], v7 offset:4352
    ds_read_b64_tr_b16 v[100:101], v7 offset:6144
    ds_read_b64_tr_b16 v[102:103], v7 offset:6400
    ds_read_b64_tr_b16 v[104:105], v7 offset:8192
    ds_read_b64_tr_b16 v[106:107], v7 offset:8448
    ds_read_b64_tr_b16 v[108:109], v7 offset:10240
    ds_read_b64_tr_b16 v[110:111], v7 offset:10496
    ds_read_b64_tr_b16 v[112:113], v7 offset:12288
    ds_read_b64_tr_b16 v[114:115], v7 offset:12544
    ds_read_b64_tr_b16 v[116:117], v7 offset:14336
    ds_read_b64_tr_b16 v[118:119], v7 offset:14592
    ds_read_b64_tr_b16 v[120:121], v7 offset:16384
    ds_read_b64_tr_b16 v[122:123], v7 offset:16640
    ds_read_b64_tr_b16 v[124:125], v7 offset:18432
    ds_read_b64_tr_b16 v[126:127], v7 offset:18688
    s_branch k3_q
k3_p:
    buffer_load_dwordx2 v[12:13], v5, s[8:11], s26 offen sc1
k3_q:
    s_waitcnt vmcnt(0)
    v_max_u32 v8, v12, v13
    v_cmp_eq_u32 vcc, -1, v8
    s_cbranch_vccz k3_p_ok
    s_add_u32 s50, s50, 1
    s_cmp_lt_u32 s50, 32768
    s_cbranch_scc1 k3_p
k3_p_ok:
    ds_write_b64 v4, v[12:13]
    s_waitcnt lgkmcnt(0)
    s_barrier
    ds_read_b128 v[32:35], v10 offset:0
    ds_read_b128 v[36:39], v10 offset:64
    ds_read_b128 v[40:43], v10 offset:128
    ds_read_b128 v[44:47], v10 offset:192
    ds_read_b128 v[48:51], v10 offset:256
    ds_read_b128 v[52:55], v10 offset:320
    ds_read_b128 v[56:59], v10 offset:384
    ds_read_b128 v[60:63], v10 offset:448
    ds_read_b128 v[64:67], v10 offset:512
    ds_read_b128 v[68:71], v10 offset:576
    s_lshl_b32 s27, s3, 8
    s_waitcnt lgkmcnt(9)
    v_mfma_f32_16x16x32_bf16 v[84:87], v[32:35], v[88:91], 0
    s_waitcnt lgkmcnt(8)
    v_mfma_f32_16x16x32_bf16 v[84:87], v[36:39], v[92:95], v[84:87]
    s_waitcnt lgkmcnt(7)
    v_mfma_f32_16x16x32_bf16 v[84:87], v[40:43], v[96:99], v[84:87]
    s_waitcnt lgkmcnt(6)
    v_mfma_f32_16x16x32_bf16 v[84:87], v[44:47], v[100:103], v[84:87]
    s_waitcnt lgkmcnt(5)
    v_mfma_f32_16x16x32_bf16 v[84:87], v[48:51], v[104:107], v[84:87]
    s_waitcnt lgkmcnt(4)
    v_mfma_f32_16x16x32_bf16 v[84:87], v[52:55], v[108:111], v[84:87]
    s_waitcnt lgkmcnt(3)
    v_mfma_f32_16x16x32_bf16 v[84:87], v[56:59], v[112:115], v[84:87]
    s_waitcnt lgkmcnt(2)
    v_mfma_f32_16x16x32_bf16 v[84:87], v[60:63], v[116:119], v[84:87]
    s_waitcnt lgkmcnt(1)
    v_mfma_f32_16x16x32_bf16 v[84:87], v[64:67], v[120:123], v[84:87]
    s_waitcnt lgkmcnt(0)
    v_mfma_f32_16x16x32_bf16 v[84:87], v[68:71], v[124:127], v[84:87]
    v_lshl_add_u32 v7, v0, 2, s27
    v_and_b32 v8, 47, v0
    v_and_b32 v9, 1, v2
    v_lshlrev_b32 v8, 2, v8
    v_lshl_add_u32 v8, v9, 8, v8
    s_nop 2
    ds_write_b32 v7, v84 offset:28672
    s_waitcnt lgkmcnt(0)
    s_barrier
    s_cmp_lg_u32 s3, 0
    s_cbranch_scc1 k_end
    ds_read_b32 v32, v8 offset:28672
    ds_read_b32 v33, v8 offset:29184
    ds_read_b32 v34, v8 offset:29696
    ds_read_b32 v35, v8 offset:30208
    v_and_b32 v7, 1, v0
    v_cmp_eq_u32 vcc, 0, v7
    v_lshlrev_b32 v16, 1, v0
    s_lshl_b32 s18, s48, 7
    s_add_u32 s18, s18, 2637824
    s_waitcnt lgkmcnt(0)
    v_add_f32 v24, v32, v33
    v_add_f32 v25, v34, v35
    v_cvt_pk_bf16_f32 v24, v24, v25
    v_lshlrev_b32 v25, 16, v24
    v_and_b32 v24, s25, v24
    v_mul_f32 v26, 0xbfb8aa3b, v25
    v_exp_f32 v26, v26
    s_nop 0
    v_add_f32 v26, 1.0, v26
    v_rcp_f32 v26, v26
    s_nop 0
    v_mul_f32 v25, v25, v26
    v_cvt_pk_bf16_f32 v25, v25, v25
    v_and_b32 v25, s25, v25
    v_mul_f32 v24, v24, v25
    s_nop 1
    v_mov_b32_dpp v25, v24 quad_perm:[1,1,3,3] row_mask:0xf bank_mask:0xf
    v_cvt_pk_bf16_f32 v24, v24, v25
    v_min_u32 v24, -2, v24
    s_and_saveexec_b64 s[36:37], vcc
    buffer_store_dword v24, v16, s[8:11], s18 offen sc1
    s_endpgm
k4:
    buffer_load_dwordx4 v114, s[40:43], s61 offen lds
    s_addk_i32 m0, 1024
    s_add_u32 s61, s61, s49
    s_sub_u32 s60, s60, 1
    s_cmp_lg_u32 s60, 0
    s_cbranch_scc1 k4
    s_mul_i32 s16, s3, 768
    s_add_u32 s17, s16, 2637824
    v_min_u32 v5, 47, v0
    v_lshlrev_b32 v5, 4, v5
    v_add_u32 v4, s16, v5
    v_lshrrev_b32 v10, 3, v1
    v_lshlrev_b32 v10, 6, v10
    s_lshl_b32 s18, s48, 5
    s_mul_i32 s19, s3, 12288
    v_xor_b32 v7, s48, v2
    v_cmp_gt_u32 vcc, 32, v0
    v_mov_b32 v18, s20
    v_mov_b32 v19, s21
    v_cndmask_b32 v16, v17, v16, vcc
    v_cndmask_b32 v18, v19, v18, vcc
    v_and_b32 v17, 14, v1
    v_lshl_add_u32 v17, v17, 1, v16
    v_add_u32 v17, s18, v17
    s_cmp_lg_u32 s3, 0
    s_cbranch_scc1 k4_h_ok
k4_h:
    buffer_load_dword v20, v17, s[8:11], s26 offen sc1
    buffer_load_dword v21, v17, s[8:11], s26 offen offset:1280 sc1
    buffer_load_dword v22, v16, s[8:11], s26 offen offset:2560 sc1
    s_waitcnt vmcnt(0)
    v_max3_u32 v8, v20, v21, v22
    v_cmp_eq_u32 vcc, -1, v8
    s_cbranch_vccz k4_h_ok
    s_add_u32 s50, s50, 1
    s_cmp_lt_u32 s50, 32768
    s_cbranch_scc1 k4_h
k4_h_ok:
    s_waitcnt vmcnt(0)
    buffer_load_dwordx4 v[12:15], v5, s[8:11], s17 offen sc1
    v_and_b32 v7, 1, v7
    v_lshl_add_u32 v7, v7, 5, v6
    s_add_u32 s19, s19, 32768
    v_add_u32 v7, s19, v7
    v_lshl_add_u32 v10, v2, 4, v10
    v_add_u32 v10, s16, v10
    ds_read_b64_tr_b16 v[88:89], v7 offset:0
    ds_read_b64_tr_b16 v[90:91], v7 offset:256
    ds_read_b64_tr_b16 v[92:93], v7 offset:2048
    ds_read_b64_tr_b16 v[94:95], v7 offset:2304
    ds_read_b64_tr_b16 v[96:97], v7 offset:4096
    ds_read_b64_tr_b16 v[98:99], v7 offset:4352
    ds_read_b64_tr_b16 v[100:101], v7 offset:6144
    ds_read_b64_tr_b16 v[102:103], v7 offset:6400
    ds_read_b64_tr_b16 v[104:105], v7 offset:8192
    ds_read_b64_tr_b16 v[106:107], v7 offset:8448
    ds_read_b64_tr_b16 v[108:109], v7 offset:10240
    ds_read_b64_tr_b16 v[110:111], v7 offset:10496
    s_branch k4_q
k4_p:
    buffer_load_dwordx4 v[12:15], v5, s[8:11], s17 offen sc1
k4_q:
    s_waitcnt vmcnt(0)
    v_max3_u32 v8, v12, v13, v14
    v_max_u32 v8, v8, v15
    v_cmp_eq_u32 vcc, -1, v8
    s_cbranch_vccz k4_p_ok
    s_add_u32 s50, s50, 1
    s_cmp_lt_u32 s50, 32768
    s_cbranch_scc1 k4_p
k4_p_ok:
    ds_write_b128 v4, v[12:15]
    s_waitcnt lgkmcnt(0)
    ds_read_b128 v[32:35], v10 offset:0
    ds_read_b128 v[36:39], v10 offset:128
    ds_read_b128 v[40:43], v10 offset:256
    ds_read_b128 v[44:47], v10 offset:384
    ds_read_b128 v[48:51], v10 offset:512
    ds_read_b128 v[52:55], v10 offset:640
    s_lshl_b32 s27, s3, 8
    s_waitcnt lgkmcnt(5)
    v_mfma_f32_16x16x32_bf16 v[84:87], v[32:35], v[88:91], 0
    s_waitcnt lgkmcnt(4)
    v_mfma_f32_16x16x32_bf16 v[84:87], v[36:39], v[92:95], v[84:87]
    s_waitcnt lgkmcnt(3)
    v_mfma_f32_16x16x32_bf16 v[84:87], v[40:43], v[96:99], v[84:87]
    s_waitcnt lgkmcnt(2)
    v_mfma_f32_16x16x32_bf16 v[84:87], v[44:47], v[100:103], v[84:87]
    s_waitcnt lgkmcnt(1)
    v_mfma_f32_16x16x32_bf16 v[84:87], v[48:51], v[104:107], v[84:87]
    s_waitcnt lgkmcnt(0)
    v_mfma_f32_16x16x32_bf16 v[84:87], v[52:55], v[108:111], v[84:87]
    v_lshl_add_u32 v7, v0, 2, s27
    v_and_b32 v8, 47, v0
    v_and_b32 v9, 1, v2
    v_lshlrev_b32 v8, 2, v8
    v_lshl_add_u32 v8, v9, 8, v8
    s_nop 2
    ds_write_b32 v7, v84 offset:28672
    s_waitcnt lgkmcnt(0)
    s_barrier
    s_cmp_lg_u32 s3, 0
    s_cbranch_scc1 k_end
    ds_read_b32 v32, v29 offset:28672
    ds_read_b32 v33, v29 offset:28928
    ds_read_b32 v34, v29 offset:29184
    ds_read_b32 v35, v29 offset:29440
    ds_read_b32 v36, v29 offset:29696
    ds_read_b32 v37, v29 offset:29952
    ds_read_b32 v38, v29 offset:30208
    ds_read_b32 v39, v29 offset:30464
    v_and_b32 v7, 16, v0
    v_cmp_eq_u32 vcc, 0, v7
    s_waitcnt lgkmcnt(0)
    v_add_f32 v32, v32, v33
    v_add_f32 v34, v34, v35
    v_add_f32 v36, v36, v37
    v_add_f32 v38, v38, v39
    v_add_f32 v24, v32, v34
    v_add_f32 v25, v36, v38
    v_ashrrev_i32 v19, 31, v18
    v_not_b32 v19, v19
    v_or_b32 v19, 0x80000000, v19
    v_xor_b32 v18, v18, v19
    v_and_b32 v18, s25, v18
    v_mul_f32 v18, 0xbfb8aa3b, v18
    v_exp_f32 v18, v18
    v_add_f32 v24, v24, v25
    v_add_f32 v18, 1.0, v18
    v_rcp_f32 v18, v18
    v_and_b32 v19, 1, v1
    v_lshlrev_b32 v19, 4, v19
    v_cvt_pk_bf16_f32 v24, v24, v18
    v_lshlrev_b32 v25, 16, v24
    v_and_b32 v24, s25, v24
    v_mul_f32 v24, v24, v25
    v_cvt_pk_bf16_f32 v24, v24, v24
    v_and_b32 v24, s25, v24
    v_lshrrev_b32 v20, v19, v20
    v_lshrrev_b32 v21, v19, v21
    v_lshlrev_b32 v20, 16, v20
    v_lshlrev_b32 v21, 16, v21
    v_and_b32 v22, 0x7ff, v22
    v_mul_u32_u24 v22, 1280, v22
    v_add_f32 v24, v24, v20
    v_cvt_pk_bf16_f32 v24, v24, v24
    v_and_b32 v24, s25, v24
    v_add_f32 v24, v24, v21
    v_cvt_pk_bf16_f32 v24, v24, v24
    v_lshl_add_u32 v22, v1, 1, v22
    s_and_saveexec_b64 s[36:37], vcc
    buffer_store_short v24, v22, s[32:35], s18 offen sc1
k_end:
    s_endpgm
.section .rodata,"a"
.p2align 6
.amdhsa_kernel sequential_preLN__spectral_fnet__moe_arch_mod__prompt_kernel
  .amdhsa_next_free_vgpr 240
  .amdhsa_next_free_sgpr 64
  .amdhsa_accum_offset 240
  .amdhsa_group_segment_fixed_size 0
  .amdhsa_kernarg_size 104
  .amdhsa_user_sgpr_count 2
  .amdhsa_user_sgpr_kernarg_segment_ptr 1
  .amdhsa_system_sgpr_workgroup_id_x 1
.end_amdhsa_kernel
```
